```python
import torch

def _softmax(x, axis=-1):
    return torch.softmax(x, dim=axis)
def _gelu(x):
    return torch.nn.functional.gelu(x, approximate="tanh")
def _silu(x):
    return torch.nn.functional.silu(x)
def _sigmoid(x):
    return torch.sigmoid(x)
def _layernorm(x, axis=-1, eps=1e-5):
    m = x.mean(dim=axis, keepdim=True)
    v = x.var(dim=axis, keepdim=True, unbiased=False)
    return (x - m) / torch.sqrt(v + eps)
def _scatter_add(tgt, idx, src, axis=0):
    return tgt.clone().index_add_(axis, idx, src)
def _segment_sum(src, seg, n):
    out = torch.zeros((n,) + src.shape[1:], dtype=src.dtype)
    return out.index_add_(0, seg, src)
def _pad(x, pw):
    flat = tuple(v for pair in reversed(pw) for v in pair)
    return torch.nn.functional.pad(x, flat)

kernel_name = 'standalone__gqa_block_cached__sampling'

def setup_inputs():

    _w = (lambda a: (lambda t: t.to(torch.bfloat16) if t.is_floating_point() else t)(torch.as_tensor(a)))
    B, Sq, D = 8, 1, 448
    Hq, Hkv, Sk, Dh = 16, 8, 8192, 256
    assert Hq % Hkv == 0, (Hq, Hkv)
    return {
        "x": _w((lambda *s: torch.randn(*s, dtype=torch.bfloat16) * 0.8)(B, Sq, D)),
        "k_cache": _w((lambda *s: torch.randn(*s, dtype=torch.bfloat16) * 0.8)(B, Hkv, Sk, Dh)),
        "v_cache": _w((lambda *s: torch.randn(*s, dtype=torch.bfloat16) * 0.05)(B, Hkv, Sk, Dh)),
        "wq": _w((lambda *s: torch.randn(*s, dtype=torch.bfloat16) * 0.8)(D, Hq * Dh) * (D ** -0.5)),
        "wo": _w((lambda *s: torch.randn(*s, dtype=torch.bfloat16) * 0.05)(Hq * Dh, D) * ((Hq * Dh) ** -0.5)),
    }

def reference(x, k_cache, v_cache, wq, wo):
    B, Sq, D = x.shape
    Hq, Dh = 16, 256
    Hkv = k_cache.shape[1]
    rep = Hq // Hkv
    q = (lambda x, *d: x.permute(*d))((x @ wq).reshape(B, Sq, Hq, Dh), 0, 2, 1, 3)
    k = (lambda x, n, axis: torch.repeat_interleave(x, n, dim=axis))(k_cache, rep, axis=1)
    v = (lambda x, n, axis: torch.repeat_interleave(x, n, dim=axis))(v_cache, rep, axis=1)
    scores = torch.einsum("bhqd,bhkd->bhqk", q, k) * (Dh ** -0.5)
    p = _softmax(scores, axis=-1)
    o = torch.einsum("bhqk,bhkd->bhqd", p, v)
    return (lambda x, *d: x.permute(*d))(o, 0, 2, 1, 3).reshape(B, Sq, Hq * Dh) @ wo
```

```asm
; @launch grid=(256,1,1) block=(320,1,1) lds=160192
.amdgcn_target "amdgcn-amd-amdhsa--gfx950"
.text
.globl standalone__gqa_block_cached__sampling_kernel
.p2align 8
.type standalone__gqa_block_cached__sampling_kernel,@function
standalone__gqa_block_cached__sampling_kernel:
s_cmp_ge_u32 s2, 256
s_cbranch_scc1 L_end
s_load_dwordx16 s[64:79], s[0:1], 0
v_lshrrev_b32 v2, 6, v0
v_and_b32 v1, 63, v0
s_nop 0
v_readfirstlane_b32 s28, v2
s_lshr_b32 s29, s2, 3
s_and_b32 s30, s2, 7
s_lshr_b32 s31, s29, 2
s_and_b32 s32, s29, 3
s_lshl_b32 s33, s32, 3
s_add_u32 s33, s33, s31
s_mov_b32 s92, 0x00030003
s_mov_b32 s93, 0x00030003
v_lshlrev_b32 v2, 4, v1
v_and_b32 v26, 15, v1
v_lshrrev_b32 v27, 4, v1
v_mov_b32 v9, 0
s_waitcnt lgkmcnt(0)
s_mov_b32 s12, s78
s_and_b32 s13, s79, 0xffff
s_mov_b32 s14, 4194304
s_mov_b32 s15, 0x00020000
s_and_b32 s67, s67, 0xffff
s_and_b32 s69, s69, 0xffff
s_cmp_eq_u32 s28, 4
s_cbranch_scc1 L_helper
s_mov_b32 s8, s66
s_and_b32 s9, s67, 0xffff
s_mov_b32 s10, 268435456
s_mov_b32 s11, 0x00020000
s_mov_b32 s16, s72
s_and_b32 s17, s73, 0xffff
s_mov_b32 s18, 3670016
s_mov_b32 s19, 0x00020000
s_lshl_b32 s58, s33, 22
s_mul_i32 s59, s30, 524288
s_mul_i32 s60, s28, 4096
s_add_u32 s34, s58, s59
s_add_u32 s34, s34, s60
s_mov_b32 s38, s34
s_add_u32 s58, s58, 134217728
s_mul_i32 s59, s30, 327680
s_add_u32 s53, s58, s59
s_add_u32 s53, s53, s60
s_add_u32 s54, s58, 2621440
s_mov_b32 s35, 16
s_mov_b32 s39, 16
s_mov_b32 s36, 32768
s_mov_b32 s37, 16384
s_mov_b32 s40, 0
s_mov_b32 s41, 0
s_mul_i32 s43, s28, 33792
s_mov_b32 s42, s43
s_mov_b32 s45, s43
s_add_u32 s44, s43, 33792
s_mov_b32 s47, 0
s_mov_b32 s48, 0
s_mov_b32 s49, 0
s_mov_b32 s50, 0
s_mov_b32 s51, 0
s_mov_b32 s52, 0
s_lshl_b32 s55, s29, 8
s_add_u32 s55, s55, 65536
s_mov_b32 s62, 0x3db8aa3b
v_mov_b32 v8, 1
s_barrier
s_add_u32 s58, s34, s37
s_add_u32 m0, s42, 0
s_nop 0
buffer_load_dwordx4 v2, s[8:11], s34 offen offset:0 nt lds
s_add_u32 m0, s42, 32
s_nop 0
buffer_load_dwordx4 v2, s[8:11], s34 offen offset:1024 nt lds
s_add_u32 m0, s42, 64
s_nop 0
buffer_load_dwordx4 v2, s[8:11], s34 offen offset:2048 nt lds
s_add_u32 m0, s42, 96
s_nop 0
buffer_load_dwordx4 v2, s[8:11], s34 offen offset:3072 nt lds
s_add_u32 m0, s42, 4224
s_nop 0
buffer_load_dwordx4 v2, s[8:11], s58 offen offset:0 nt lds
s_add_u32 m0, s42, 4256
s_nop 0
buffer_load_dwordx4 v2, s[8:11], s58 offen offset:1024 nt lds
s_add_u32 m0, s42, 4288
s_nop 0
buffer_load_dwordx4 v2, s[8:11], s58 offen offset:2048 nt lds
s_add_u32 m0, s42, 4320
s_nop 0
buffer_load_dwordx4 v2, s[8:11], s58 offen offset:3072 nt lds
s_add_u32 s42, s42, 8448
s_cmp_eq_u32 s42, s44
s_cselect_b32 s42, s43, s42
s_add_u32 s34, s34, s36
s_sub_u32 s35, s35, 1
s_add_u32 s58, s34, s37
s_add_u32 m0, s42, 0
s_nop 0
buffer_load_dwordx4 v2, s[8:11], s34 offen offset:0 nt lds
s_add_u32 m0, s42, 32
s_nop 0
buffer_load_dwordx4 v2, s[8:11], s34 offen offset:1024 nt lds
s_add_u32 m0, s42, 64
s_nop 0
buffer_load_dwordx4 v2, s[8:11], s34 offen offset:2048 nt lds
s_add_u32 m0, s42, 96
s_nop 0
buffer_load_dwordx4 v2, s[8:11], s34 offen offset:3072 nt lds
s_add_u32 m0, s42, 4224
s_nop 0
buffer_load_dwordx4 v2, s[8:11], s58 offen offset:0 nt lds
s_add_u32 m0, s42, 4256
s_nop 0
buffer_load_dwordx4 v2, s[8:11], s58 offen offset:1024 nt lds
s_add_u32 m0, s42, 4288
s_nop 0
buffer_load_dwordx4 v2, s[8:11], s58 offen offset:2048 nt lds
s_add_u32 m0, s42, 4320
s_nop 0
buffer_load_dwordx4 v2, s[8:11], s58 offen offset:3072 nt lds
s_add_u32 s42, s42, 8448
s_cmp_eq_u32 s42, s44
s_cselect_b32 s42, s43, s42
s_add_u32 s34, s34, s36
s_sub_u32 s35, s35, 1
s_add_u32 s58, s34, s37
s_add_u32 m0, s42, 0
s_nop 0
buffer_load_dwordx4 v2, s[8:11], s34 offen offset:0 nt lds
s_add_u32 m0, s42, 32
s_nop 0
buffer_load_dwordx4 v2, s[8:11], s34 offen offset:1024 nt lds
s_add_u32 m0, s42, 64
s_nop 0
buffer_load_dwordx4 v2, s[8:11], s34 offen offset:2048 nt lds
s_add_u32 m0, s42, 96
s_nop 0
buffer_load_dwordx4 v2, s[8:11], s34 offen offset:3072 nt lds
s_add_u32 m0, s42, 4224
s_nop 0
buffer_load_dwordx4 v2, s[8:11], s58 offen offset:0 nt lds
s_add_u32 m0, s42, 4256
s_nop 0
buffer_load_dwordx4 v2, s[8:11], s58 offen offset:1024 nt lds
s_add_u32 m0, s42, 4288
s_nop 0
buffer_load_dwordx4 v2, s[8:11], s58 offen offset:2048 nt lds
s_add_u32 m0, s42, 4320
s_nop 0
buffer_load_dwordx4 v2, s[8:11], s58 offen offset:3072 nt lds
s_add_u32 s42, s42, 8448
s_cmp_eq_u32 s42, s44
s_cselect_b32 s42, s43, s42
s_add_u32 s34, s34, s36
s_sub_u32 s35, s35, 1
v_and_b32 v14, 7, v26
v_mul_u32_u24 v3, 1056, v14
v_lshrrev_b32 v14, 3, v26
v_lshl_add_u32 v3, v14, 9, v3
v_lshl_add_u32 v3, v27, 4, v3
v_lshrrev_b32 v14, 2, v1
v_and_b32 v14, 7, v14
v_mul_u32_u24 v4, 1056, v14
v_lshrrev_b32 v14, 5, v1
v_lshl_add_u32 v4, v14, 9, v4
v_and_b32 v14, 3, v1
v_lshl_add_u32 v4, v14, 3, v4
v_and_b32 v14, 1, v26
v_lshlrev_b32 v5, 10, v14
v_lshl_add_u32 v5, v27, 4, v5
s_lshl_b32 s61, s28, 11
s_add_u32 s61, s61, 135168
v_add_u32 v5, s61, v5
s_waitcnt vmcnt(16)
s_add_u32 s58, s34, s37
s_add_u32 m0, s42, 0
s_nop 0
buffer_load_dwordx4 v2, s[8:11], s34 offen offset:0 nt lds
s_add_u32 m0, s42, 32
s_nop 0
buffer_load_dwordx4 v2, s[8:11], s34 offen offset:1024 nt lds
s_add_u32 m0, s42, 64
s_nop 0
buffer_load_dwordx4 v2, s[8:11], s34 offen offset:2048 nt lds
s_add_u32 m0, s42, 96
s_nop 0
buffer_load_dwordx4 v2, s[8:11], s34 offen offset:3072 nt lds
s_add_u32 m0, s42, 4224
s_nop 0
buffer_load_dwordx4 v2, s[8:11], s58 offen offset:0 nt lds
s_add_u32 m0, s42, 4256
s_nop 0
buffer_load_dwordx4 v2, s[8:11], s58 offen offset:1024 nt lds
s_add_u32 m0, s42, 4288
s_nop 0
buffer_load_dwordx4 v2, s[8:11], s58 offen offset:2048 nt lds
s_add_u32 m0, s42, 4320
s_nop 0
buffer_load_dwordx4 v2, s[8:11], s58 offen offset:3072 nt lds
s_add_u32 s42, s42, 8448
s_cmp_eq_u32 s42, s44
s_cselect_b32 s42, s43, s42
s_add_u32 s34, s34, s36
s_sub_u32 s35, s35, 1
s_waitcnt vmcnt(16)
v_add_u32 v6, s45, v3
ds_read_b128 v[64:67], v6 offset:0
ds_read_b128 v[68:71], v6 offset:64
ds_read_b128 v[72:75], v6 offset:128
ds_read_b128 v[76:79], v6 offset:192
ds_read_b128 v[80:83], v6 offset:256
ds_read_b128 v[84:87], v6 offset:320
ds_read_b128 v[88:91], v6 offset:384
ds_read_b128 v[92:95], v6 offset:448
s_add_u32 s45, s45, 8448
s_cmp_eq_u32 s45, s44
s_cselect_b32 s45, s43, s45
s_waitcnt lgkmcnt(0)
s_add_u32 s58, s34, s37
s_add_u32 m0, s42, 0
s_nop 0
buffer_load_dwordx4 v2, s[8:11], s34 offen offset:0 nt lds
s_add_u32 m0, s42, 32
s_nop 0
buffer_load_dwordx4 v2, s[8:11], s34 offen offset:1024 nt lds
s_add_u32 m0, s42, 64
s_nop 0
buffer_load_dwordx4 v2, s[8:11], s34 offen offset:2048 nt lds
s_add_u32 m0, s42, 96
s_nop 0
buffer_load_dwordx4 v2, s[8:11], s34 offen offset:3072 nt lds
s_add_u32 m0, s42, 4224
s_nop 0
buffer_load_dwordx4 v2, s[8:11], s58 offen offset:0 nt lds
s_add_u32 m0, s42, 4256
s_nop 0
buffer_load_dwordx4 v2, s[8:11], s58 offen offset:1024 nt lds
s_add_u32 m0, s42, 4288
s_nop 0
buffer_load_dwordx4 v2, s[8:11], s58 offen offset:2048 nt lds
s_add_u32 m0, s42, 4320
s_nop 0
buffer_load_dwordx4 v2, s[8:11], s58 offen offset:3072 nt lds
s_add_u32 s42, s42, 8448
s_cmp_eq_u32 s42, s44
s_cselect_b32 s42, s43, s42
s_add_u32 s34, s34, s36
s_sub_u32 s35, s35, 1
s_waitcnt vmcnt(16)
v_add_u32 v6, s45, v3
ds_read_b128 v[96:99], v6 offset:0
ds_read_b128 v[100:103], v6 offset:64
ds_read_b128 v[104:107], v6 offset:128
ds_read_b128 v[108:111], v6 offset:192
ds_read_b128 v[112:115], v6 offset:256
ds_read_b128 v[116:119], v6 offset:320
ds_read_b128 v[120:123], v6 offset:384
ds_read_b128 v[124:127], v6 offset:448
s_add_u32 s45, s45, 8448
s_cmp_eq_u32 s45, s44
s_cselect_b32 s45, s43, s45
s_waitcnt lgkmcnt(0)
s_add_u32 s58, s34, s37
s_add_u32 m0, s42, 0
s_nop 0
buffer_load_dwordx4 v2, s[8:11], s34 offen offset:0 nt lds
s_add_u32 m0, s42, 32
s_nop 0
buffer_load_dwordx4 v2, s[8:11], s34 offen offset:1024 nt lds
s_add_u32 m0, s42, 64
s_nop 0
buffer_load_dwordx4 v2, s[8:11], s34 offen offset:2048 nt lds
s_add_u32 m0, s42, 96
s_nop 0
buffer_load_dwordx4 v2, s[8:11], s34 offen offset:3072 nt lds
s_add_u32 m0, s42, 4224
s_nop 0
buffer_load_dwordx4 v2, s[8:11], s58 offen offset:0 nt lds
s_add_u32 m0, s42, 4256
s_nop 0
buffer_load_dwordx4 v2, s[8:11], s58 offen offset:1024 nt lds
s_add_u32 m0, s42, 4288
s_nop 0
buffer_load_dwordx4 v2, s[8:11], s58 offen offset:2048 nt lds
s_add_u32 m0, s42, 4320
s_nop 0
buffer_load_dwordx4 v2, s[8:11], s58 offen offset:3072 nt lds
s_add_u32 s42, s42, 8448
s_cmp_eq_u32 s42, s44
s_cselect_b32 s42, s43, s42
s_add_u32 s34, s34, s36
s_sub_u32 s35, s35, 1
s_waitcnt vmcnt(16)
v_add_u32 v6, s45, v3
ds_read_b128 v[128:131], v6 offset:0
ds_read_b128 v[132:135], v6 offset:64
ds_read_b128 v[136:139], v6 offset:128
ds_read_b128 v[140:143], v6 offset:192
ds_read_b128 v[144:147], v6 offset:256
ds_read_b128 v[148:151], v6 offset:320
ds_read_b128 v[152:155], v6 offset:384
ds_read_b128 v[156:159], v6 offset:448
s_add_u32 s45, s45, 8448
s_cmp_eq_u32 s45, s44
s_cselect_b32 s45, s43, s45
s_waitcnt lgkmcnt(0)
s_add_u32 s58, s34, s37
s_add_u32 m0, s42, 0
s_nop 0
buffer_load_dwordx4 v2, s[8:11], s34 offen offset:0 nt lds
s_add_u32 m0, s42, 32
s_nop 0
buffer_load_dwordx4 v2, s[8:11], s34 offen offset:1024 nt lds
s_add_u32 m0, s42, 64
s_nop 0
buffer_load_dwordx4 v2, s[8:11], s34 offen offset:2048 nt lds
s_add_u32 m0, s42, 96
s_nop 0
buffer_load_dwordx4 v2, s[8:11], s34 offen offset:3072 nt lds
s_add_u32 m0, s42, 4224
s_nop 0
buffer_load_dwordx4 v2, s[8:11], s58 offen offset:0 nt lds
s_add_u32 m0, s42, 4256
s_nop 0
buffer_load_dwordx4 v2, s[8:11], s58 offen offset:1024 nt lds
s_add_u32 m0, s42, 4288
s_nop 0
buffer_load_dwordx4 v2, s[8:11], s58 offen offset:2048 nt lds
s_add_u32 m0, s42, 4320
s_nop 0
buffer_load_dwordx4 v2, s[8:11], s58 offen offset:3072 nt lds
s_add_u32 s42, s42, 8448
s_cmp_eq_u32 s42, s44
s_cselect_b32 s42, s43, s42
s_add_u32 s34, s34, s36
s_sub_u32 s35, s35, 1
s_waitcnt vmcnt(16)
v_add_u32 v6, s45, v3
ds_read_b128 v[160:163], v6 offset:0
ds_read_b128 v[164:167], v6 offset:64
ds_read_b128 v[168:171], v6 offset:128
ds_read_b128 v[172:175], v6 offset:192
ds_read_b128 v[176:179], v6 offset:256
ds_read_b128 v[180:183], v6 offset:320
ds_read_b128 v[184:187], v6 offset:384
ds_read_b128 v[188:191], v6 offset:448
s_add_u32 s45, s45, 8448
s_cmp_eq_u32 s45, s44
s_cselect_b32 s45, s43, s45
s_waitcnt lgkmcnt(0)
s_add_u32 s58, s34, s37
s_add_u32 m0, s42, 0
s_nop 0
buffer_load_dwordx4 v2, s[8:11], s34 offen offset:0 nt lds
s_add_u32 m0, s42, 32
s_nop 0
buffer_load_dwordx4 v2, s[8:11], s34 offen offset:1024 nt lds
s_add_u32 m0, s42, 64
s_nop 0
buffer_load_dwordx4 v2, s[8:11], s34 offen offset:2048 nt lds
s_add_u32 m0, s42, 96
s_nop 0
buffer_load_dwordx4 v2, s[8:11], s34 offen offset:3072 nt lds
s_add_u32 m0, s42, 4224
s_nop 0
buffer_load_dwordx4 v2, s[8:11], s58 offen offset:0 nt lds
s_add_u32 m0, s42, 4256
s_nop 0
buffer_load_dwordx4 v2, s[8:11], s58 offen offset:1024 nt lds
s_add_u32 m0, s42, 4288
s_nop 0
buffer_load_dwordx4 v2, s[8:11], s58 offen offset:2048 nt lds
s_add_u32 m0, s42, 4320
s_nop 0
buffer_load_dwordx4 v2, s[8:11], s58 offen offset:3072 nt lds
s_add_u32 s42, s42, 8448
s_cmp_eq_u32 s42, s44
s_cselect_b32 s42, s43, s42
s_add_u32 s34, s34, s36
s_sub_u32 s35, s35, 1
s_mov_b32 s46, 3
s_barrier
v_and_b32 v14, 1, v26
v_lshlrev_b32 v14, 9, v14
v_lshl_add_u32 v14, v27, 4, v14
v_add_u32 v14, 149504, v14
ds_read_b128 v[32:35], v14 offset:0
ds_read_b128 v[36:39], v14 offset:64
ds_read_b128 v[40:43], v14 offset:128
ds_read_b128 v[44:47], v14 offset:192
ds_read_b128 v[48:51], v14 offset:256
ds_read_b128 v[52:55], v14 offset:320
ds_read_b128 v[56:59], v14 offset:384
ds_read_b128 v[60:63], v14 offset:448
s_waitcnt lgkmcnt(0)
v_mov_b32 v13, 0xff61b1e6
v_mfma_f32_16x16x32_bf16 v[20:23], v[64:67], v[32:35], 0
v_mfma_f32_16x16x32_bf16 v[20:23], v[68:71], v[36:39], v[20:23]
v_mfma_f32_16x16x32_bf16 v[20:23], v[72:75], v[40:43], v[20:23]
v_mfma_f32_16x16x32_bf16 v[20:23], v[76:79], v[44:47], v[20:23]
v_mfma_f32_16x16x32_bf16 v[20:23], v[80:83], v[48:51], v[20:23]
v_mfma_f32_16x16x32_bf16 v[20:23], v[84:87], v[52:55], v[20:23]
v_mfma_f32_16x16x32_bf16 v[20:23], v[88:91], v[56:59], v[20:23]
v_mfma_f32_16x16x32_bf16 v[20:23], v[92:95], v[60:63], v[20:23]
s_nop 7
s_nop 1
v_cvt_pk_bf16_f32 v14, v20, v21
v_cvt_pk_bf16_f32 v15, v22, v23
v_lshlrev_b32 v20, 16, v14
v_and_b32 v21, 0xffff0000, v14
v_lshlrev_b32 v22, 16, v15
v_and_b32 v23, 0xffff0000, v15
v_max3_f32 v13, v20, v21, v13
v_max3_f32 v13, v22, v23, v13
s_mov_b64 exec, s[92:93]
ds_write_b128 v5, v[20:23] offset:0
s_mov_b64 exec, -1
s_nop 3
v_mfma_f32_16x16x32_bf16 v[20:23], v[96:99], v[32:35], 0
v_mfma_f32_16x16x32_bf16 v[20:23], v[100:103], v[36:39], v[20:23]
v_mfma_f32_16x16x32_bf16 v[20:23], v[104:107], v[40:43], v[20:23]
v_mfma_f32_16x16x32_bf16 v[20:23], v[108:111], v[44:47], v[20:23]
v_mfma_f32_16x16x32_bf16 v[20:23], v[112:115], v[48:51], v[20:23]
v_mfma_f32_16x16x32_bf16 v[20:23], v[116:119], v[52:55], v[20:23]
v_mfma_f32_16x16x32_bf16 v[20:23], v[120:123], v[56:59], v[20:23]
v_mfma_f32_16x16x32_bf16 v[20:23], v[124:127], v[60:63], v[20:23]
s_nop 7
s_nop 1
v_cvt_pk_bf16_f32 v14, v20, v21
v_cvt_pk_bf16_f32 v15, v22, v23
v_lshlrev_b32 v20, 16, v14
v_and_b32 v21, 0xffff0000, v14
v_lshlrev_b32 v22, 16, v15
v_and_b32 v23, 0xffff0000, v15
v_max3_f32 v13, v20, v21, v13
v_max3_f32 v13, v22, v23, v13
s_mov_b64 exec, s[92:93]
ds_write_b128 v5, v[20:23] offset:64
s_mov_b64 exec, -1
s_nop 3
v_mfma_f32_16x16x32_bf16 v[20:23], v[128:131], v[32:35], 0
v_mfma_f32_16x16x32_bf16 v[20:23], v[132:135], v[36:39], v[20:23]
v_mfma_f32_16x16x32_bf16 v[20:23], v[136:139], v[40:43], v[20:23]
v_mfma_f32_16x16x32_bf16 v[20:23], v[140:143], v[44:47], v[20:23]
v_mfma_f32_16x16x32_bf16 v[20:23], v[144:147], v[48:51], v[20:23]
v_mfma_f32_16x16x32_bf16 v[20:23], v[148:151], v[52:55], v[20:23]
v_mfma_f32_16x16x32_bf16 v[20:23], v[152:155], v[56:59], v[20:23]
v_mfma_f32_16x16x32_bf16 v[20:23], v[156:159], v[60:63], v[20:23]
s_nop 7
s_nop 1
v_cvt_pk_bf16_f32 v14, v20, v21
v_cvt_pk_bf16_f32 v15, v22, v23
v_lshlrev_b32 v20, 16, v14
v_and_b32 v21, 0xffff0000, v14
v_lshlrev_b32 v22, 16, v15
v_and_b32 v23, 0xffff0000, v15
v_max3_f32 v13, v20, v21, v13
v_max3_f32 v13, v22, v23, v13
s_mov_b64 exec, s[92:93]
ds_write_b128 v5, v[20:23] offset:128
s_mov_b64 exec, -1
s_nop 3
v_mfma_f32_16x16x32_bf16 v[20:23], v[160:163], v[32:35], 0
v_mfma_f32_16x16x32_bf16 v[20:23], v[164:167], v[36:39], v[20:23]
v_mfma_f32_16x16x32_bf16 v[20:23], v[168:171], v[40:43], v[20:23]
v_mfma_f32_16x16x32_bf16 v[20:23], v[172:175], v[44:47], v[20:23]
v_mfma_f32_16x16x32_bf16 v[20:23], v[176:179], v[48:51], v[20:23]
v_mfma_f32_16x16x32_bf16 v[20:23], v[180:183], v[52:55], v[20:23]
v_mfma_f32_16x16x32_bf16 v[20:23], v[184:187], v[56:59], v[20:23]
v_mfma_f32_16x16x32_bf16 v[20:23], v[188:191], v[60:63], v[20:23]
s_nop 7
s_nop 1
v_cvt_pk_bf16_f32 v14, v20, v21
v_cvt_pk_bf16_f32 v15, v22, v23
v_lshlrev_b32 v20, 16, v14
v_and_b32 v21, 0xffff0000, v14
v_lshlrev_b32 v22, 16, v15
v_and_b32 v23, 0xffff0000, v15
v_max3_f32 v13, v20, v21, v13
v_max3_f32 v13, v22, v23, v13
s_mov_b64 exec, s[92:93]
ds_write_b128 v5, v[20:23] offset:192
s_mov_b64 exec, -1
s_nop 3
v_mov_b32 v96, 0
v_mov_b32 v97, 0
v_mov_b32 v98, 0
v_mov_b32 v99, 0
v_mov_b32 v100, 0
v_mov_b32 v101, 0
v_mov_b32 v102, 0
v_mov_b32 v103, 0
v_mov_b32 v104, 0
v_mov_b32 v105, 0
v_mov_b32 v106, 0
v_mov_b32 v107, 0
v_mov_b32 v108, 0
v_mov_b32 v109, 0
v_mov_b32 v110, 0
v_mov_b32 v111, 0
v_mov_b32 v112, 0
v_mov_b32 v113, 0
v_mov_b32 v114, 0
v_mov_b32 v115, 0
v_mov_b32 v116, 0
v_mov_b32 v117, 0
v_mov_b32 v118, 0
v_mov_b32 v119, 0
v_mov_b32 v120, 0
v_mov_b32 v121, 0
v_mov_b32 v122, 0
v_mov_b32 v123, 0
v_mov_b32 v124, 0
v_mov_b32 v125, 0
v_mov_b32 v126, 0
v_mov_b32 v127, 0
v_mov_b32 v128, 0
v_mov_b32 v129, 0
v_mov_b32 v130, 0
v_mov_b32 v131, 0
v_mov_b32 v132, 0
v_mov_b32 v133, 0
v_mov_b32 v134, 0
v_mov_b32 v135, 0
v_mov_b32 v136, 0
v_mov_b32 v137, 0
v_mov_b32 v138, 0
v_mov_b32 v139, 0
v_mov_b32 v140, 0
v_mov_b32 v141, 0
v_mov_b32 v142, 0
v_mov_b32 v143, 0
v_mov_b32 v144, 0
v_mov_b32 v145, 0
v_mov_b32 v146, 0
v_mov_b32 v147, 0
v_mov_b32 v148, 0
v_mov_b32 v149, 0
v_mov_b32 v150, 0
v_mov_b32 v151, 0
v_mov_b32 v152, 0
v_mov_b32 v153, 0
v_mov_b32 v154, 0
v_mov_b32 v155, 0
v_mov_b32 v156, 0
v_mov_b32 v157, 0
v_mov_b32 v158, 0
v_mov_b32 v159, 0
v_mov_b32 v10, 0xff61b1e6
v_mov_b32 v12, 0
s_mov_b32 s56, 16
s_mov_b32 s57, 4
s_mov_b32 s63, 0
s_branch L_kloop
L_seg:
v_mov_b32 v13, 0xff61b1e6
s_mov_b32 s57, 0
L_kloop:
s_cmp_eq_u32 s47, 0
s_cbranch_scc1 L_wi_9_a
s_waitcnt vmcnt(0)
s_branch L_wi_9_e
L_wi_9_a:
s_waitcnt vmcnt(0)
s_cmp_eq_u32 s46, 0
s_cbranch_scc1 L_wi_9_b
s_sub_u32 s46, s46, 1
s_branch L_wi_9_e
L_wi_9_b:
s_add_u32 s58, s34, s37
s_add_u32 m0, s42, 0
s_nop 0
buffer_load_dwordx4 v2, s[8:11], s34 offen offset:0 nt lds
s_add_u32 m0, s42, 32
s_nop 0
buffer_load_dwordx4 v2, s[8:11], s34 offen offset:1024 nt lds
s_add_u32 m0, s42, 64
s_nop 0
buffer_load_dwordx4 v2, s[8:11], s34 offen offset:2048 nt lds
s_add_u32 m0, s42, 96
s_nop 0
buffer_load_dwordx4 v2, s[8:11], s34 offen offset:3072 nt lds
s_add_u32 m0, s42, 4224
s_nop 0
buffer_load_dwordx4 v2, s[8:11], s58 offen offset:0 nt lds
s_add_u32 m0, s42, 4256
s_nop 0
buffer_load_dwordx4 v2, s[8:11], s58 offen offset:1024 nt lds
s_add_u32 m0, s42, 4288
s_nop 0
buffer_load_dwordx4 v2, s[8:11], s58 offen offset:2048 nt lds
s_add_u32 m0, s42, 4320
s_nop 0
buffer_load_dwordx4 v2, s[8:11], s58 offen offset:3072 nt lds
s_add_u32 s42, s42, 8448
s_cmp_eq_u32 s42, s44
s_cselect_b32 s42, s43, s42
s_add_u32 s34, s34, s36
s_sub_u32 s35, s35, 1
s_cmp_lg_u32 s35, 0
s_cbranch_scc1 L_is_10_done
s_cmp_eq_u32 s40, 0
s_cbranch_scc0 L_is_10_nseg
s_mov_b32 s8, s68
s_mov_b32 s9, s69
s_mov_b32 s34, s38
s_mov_b32 s35, s39
s_mov_b32 s40, 1
s_branch L_is_10_done
L_is_10_nseg:
s_mov_b32 s8, s66
s_mov_b32 s9, s67
s_mov_b32 s40, 0
s_add_u32 s41, s41, 1
s_cmp_eq_u32 s41, 1
s_cbranch_scc0 L_is_10_dyn
s_mov_b32 s34, s53
s_mov_b32 s38, s53
s_mov_b32 s35, 10
s_mov_b32 s39, 10
s_branch L_is_10_done
L_is_10_dyn:
s_mov_b32 s95, 0
v_mov_b32 v18, 151816
L_is_10_okp:
ds_read_b32 v19, v18
s_waitcnt lgkmcnt(0)
v_readfirstlane_b32 s59, v19
s_add_u32 s95, s95, 1
s_cmp_eq_u32 s59, 1
s_cbranch_scc1 L_is_10_req
s_sleep 4
s_cmp_lt_u32 s95, 262144
s_cbranch_scc1 L_is_10_okp
L_is_10_req:
v_mov_b32 v8, 1
s_mov_b64 exec, 1
buffer_atomic_add v8, v9, s[12:15], s55 offen sc0 sc1
s_mov_b64 exec, -1
s_mov_b32 s47, 1
L_is_10_done:
L_wi_9_e:
v_add_u32 v6, s45, v3
ds_read_b128 v[64:67], v6 offset:0
ds_read_b128 v[68:71], v6 offset:64
ds_read_b128 v[72:75], v6 offset:128
ds_read_b128 v[76:79], v6 offset:192
ds_read_b128 v[80:83], v6 offset:256
ds_read_b128 v[84:87], v6 offset:320
ds_read_b128 v[88:91], v6 offset:384
ds_read_b128 v[92:95], v6 offset:448
s_add_u32 s45, s45, 8448
s_cmp_eq_u32 s45, s44
s_cselect_b32 s45, s43, s45
s_lshl_b32 s61, s57, 6
v_add_u32 v7, s61, v5
s_waitcnt lgkmcnt(7)
v_mfma_f32_16x16x32_bf16 v[20:23], v[64:67], v[32:35], 0
s_waitcnt lgkmcnt(6)
v_mfma_f32_16x16x32_bf16 v[20:23], v[68:71], v[36:39], v[20:23]
s_waitcnt lgkmcnt(5)
v_mfma_f32_16x16x32_bf16 v[20:23], v[72:75], v[40:43], v[20:23]
s_waitcnt lgkmcnt(4)
v_mfma_f32_16x16x32_bf16 v[20:23], v[76:79], v[44:47], v[20:23]
s_waitcnt lgkmcnt(3)
v_mfma_f32_16x16x32_bf16 v[20:23], v[80:83], v[48:51], v[20:23]
s_waitcnt lgkmcnt(2)
v_mfma_f32_16x16x32_bf16 v[20:23], v[84:87], v[52:55], v[20:23]
s_waitcnt lgkmcnt(1)
v_mfma_f32_16x16x32_bf16 v[20:23], v[88:91], v[56:59], v[20:23]
s_waitcnt lgkmcnt(0)
v_mfma_f32_16x16x32_bf16 v[20:23], v[92:95], v[60:63], v[20:23]
s_nop 7
s_nop 1
v_cvt_pk_bf16_f32 v14, v20, v21
v_cvt_pk_bf16_f32 v15, v22, v23
v_lshlrev_b32 v20, 16, v14
v_and_b32 v21, 0xffff0000, v14
v_lshlrev_b32 v22, 16, v15
v_and_b32 v23, 0xffff0000, v15
v_max3_f32 v13, v20, v21, v13
v_max3_f32 v13, v22, v23, v13
s_mov_b64 exec, s[92:93]
ds_write_b128 v7, v[20:23] offset:0
s_mov_b64 exec, -1
s_add_u32 s57, s57, 1
s_cmp_lt_u32 s57, s56
s_cbranch_scc1 L_kloop
v_mov_b32 v14, v13
s_nop 1
v_permlane16_swap_b32 v13, v14
s_nop 1
v_max_f32 v13, v13, v14
v_mov_b32 v14, v13
s_nop 1
v_permlane32_swap_b32 v13, v14
s_nop 1
v_max_f32 v13, v13, v14
v_max_f32 v13, v13, v10
v_sub_f32 v14, v10, v13
v_mul_f32 v14, s62, v14
v_exp_f32 v14, v14
v_mov_b32 v10, v13
v_mul_f32 v11, s62, v13
v_mul_f32 v12, v12, v14
v_mul_f32 v96, v96, v14
v_mul_f32 v97, v97, v14
v_mul_f32 v98, v98, v14
v_mul_f32 v99, v99, v14
v_mul_f32 v100, v100, v14
v_mul_f32 v101, v101, v14
v_mul_f32 v102, v102, v14
v_mul_f32 v103, v103, v14
v_mul_f32 v104, v104, v14
v_mul_f32 v105, v105, v14
v_mul_f32 v106, v106, v14
v_mul_f32 v107, v107, v14
v_mul_f32 v108, v108, v14
v_mul_f32 v109, v109, v14
v_mul_f32 v110, v110, v14
v_mul_f32 v111, v111, v14
v_mul_f32 v112, v112, v14
v_mul_f32 v113, v113, v14
v_mul_f32 v114, v114, v14
v_mul_f32 v115, v115, v14
v_mul_f32 v116, v116, v14
v_mul_f32 v117, v117, v14
v_mul_f32 v118, v118, v14
v_mul_f32 v119, v119, v14
v_mul_f32 v120, v120, v14
v_mul_f32 v121, v121, v14
v_mul_f32 v122, v122, v14
v_mul_f32 v123, v123, v14
v_mul_f32 v124, v124, v14
v_mul_f32 v125, v125, v14
v_mul_f32 v126, v126, v14
v_mul_f32 v127, v127, v14
v_mul_f32 v128, v128, v14
v_mul_f32 v129, v129, v14
v_mul_f32 v130, v130, v14
v_mul_f32 v131, v131, v14
v_mul_f32 v132, v132, v14
v_mul_f32 v133, v133, v14
v_mul_f32 v134, v134, v14
v_mul_f32 v135, v135, v14
v_mul_f32 v136, v136, v14
v_mul_f32 v137, v137, v14
v_mul_f32 v138, v138, v14
v_mul_f32 v139, v139, v14
v_mul_f32 v140, v140, v14
v_mul_f32 v141, v141, v14
v_mul_f32 v142, v142, v14
v_mul_f32 v143, v143, v14
v_mul_f32 v144, v144, v14
v_mul_f32 v145, v145, v14
v_mul_f32 v146, v146, v14
v_mul_f32 v147, v147, v14
v_mul_f32 v148, v148, v14
v_mul_f32 v149, v149, v14
v_mul_f32 v150, v150, v14
v_mul_f32 v151, v151, v14
v_mul_f32 v152, v152, v14
v_mul_f32 v153, v153, v14
v_mul_f32 v154, v154, v14
v_mul_f32 v155, v155, v14
v_mul_f32 v156, v156, v14
v_mul_f32 v157, v157, v14
v_mul_f32 v158, v158, v14
v_mul_f32 v159, v159, v14
s_mov_b32 s57, 0
L_vloop:
s_cmp_eq_u32 s47, 0
s_cbranch_scc1 L_wi_11_a
s_waitcnt vmcnt(0)
s_branch L_wi_11_e
L_wi_11_a:
s_waitcnt vmcnt(0)
s_cmp_eq_u32 s46, 0
s_cbranch_scc1 L_wi_11_b
s_sub_u32 s46, s46, 1
s_branch L_wi_11_e
L_wi_11_b:
s_add_u32 s58, s34, s37
s_add_u32 m0, s42, 0
s_nop 0
buffer_load_dwordx4 v2, s[8:11], s34 offen offset:0 nt lds
s_add_u32 m0, s42, 32
s_nop 0
buffer_load_dwordx4 v2, s[8:11], s34 offen offset:1024 nt lds
s_add_u32 m0, s42, 64
s_nop 0
buffer_load_dwordx4 v2, s[8:11], s34 offen offset:2048 nt lds
s_add_u32 m0, s42, 96
s_nop 0
buffer_load_dwordx4 v2, s[8:11], s34 offen offset:3072 nt lds
s_add_u32 m0, s42, 4224
s_nop 0
buffer_load_dwordx4 v2, s[8:11], s58 offen offset:0 nt lds
s_add_u32 m0, s42, 4256
s_nop 0
buffer_load_dwordx4 v2, s[8:11], s58 offen offset:1024 nt lds
s_add_u32 m0, s42, 4288
s_nop 0
buffer_load_dwordx4 v2, s[8:11], s58 offen offset:2048 nt lds
s_add_u32 m0, s42, 4320
s_nop 0
buffer_load_dwordx4 v2, s[8:11], s58 offen offset:3072 nt lds
s_add_u32 s42, s42, 8448
s_cmp_eq_u32 s42, s44
s_cselect_b32 s42, s43, s42
s_add_u32 s34, s34, s36
s_sub_u32 s35, s35, 1
s_cmp_lg_u32 s35, 0
s_cbranch_scc1 L_is_12_done
s_cmp_eq_u32 s40, 0
s_cbranch_scc0 L_is_12_nseg
s_mov_b32 s8, s68
s_mov_b32 s9, s69
s_mov_b32 s34, s38
s_mov_b32 s35, s39
s_mov_b32 s40, 1
s_branch L_is_12_done
L_is_12_nseg:
s_mov_b32 s8, s66
s_mov_b32 s9, s67
s_mov_b32 s40, 0
s_add_u32 s41, s41, 1
s_cmp_eq_u32 s41, 1
s_cbranch_scc0 L_is_12_dyn
s_mov_b32 s34, s53
s_mov_b32 s38, s53
s_mov_b32 s35, 10
s_mov_b32 s39, 10
s_branch L_is_12_done
L_is_12_dyn:
s_mov_b32 s95, 0
v_mov_b32 v18, 151816
L_is_12_okp:
ds_read_b32 v19, v18
s_waitcnt lgkmcnt(0)
v_readfirstlane_b32 s59, v19
s_add_u32 s95, s95, 1
s_cmp_eq_u32 s59, 1
s_cbranch_scc1 L_is_12_req
s_sleep 4
s_cmp_lt_u32 s95, 262144
s_cbranch_scc1 L_is_12_okp
L_is_12_req:
v_mov_b32 v8, 1
s_mov_b64 exec, 1
buffer_atomic_add v8, v9, s[12:15], s55 offen sc0 sc1
s_mov_b64 exec, -1
s_mov_b32 s47, 1
L_is_12_done:
L_wi_11_e:
s_lshl_b32 s61, s57, 6
v_add_u32 v7, s61, v5
v_add_u32 v6, s45, v4
ds_read_b128 v[28:31], v7
ds_read_b64_tr_b16 v[64:65], v6 offset:0
ds_read_b64_tr_b16 v[66:67], v6 offset:32
ds_read_b64_tr_b16 v[68:69], v6 offset:64
ds_read_b64_tr_b16 v[70:71], v6 offset:96
ds_read_b64_tr_b16 v[72:73], v6 offset:128
ds_read_b64_tr_b16 v[74:75], v6 offset:160
ds_read_b64_tr_b16 v[76:77], v6 offset:192
ds_read_b64_tr_b16 v[78:79], v6 offset:224
ds_read_b64_tr_b16 v[80:81], v6 offset:256
ds_read_b64_tr_b16 v[82:83], v6 offset:288
ds_read_b64_tr_b16 v[84:85], v6 offset:320
ds_read_b64_tr_b16 v[86:87], v6 offset:352
ds_read_b64_tr_b16 v[88:89], v6 offset:384
ds_read_b64_tr_b16 v[90:91], v6 offset:416
ds_read_b64_tr_b16 v[92:93], v6 offset:448
ds_read_b64_tr_b16 v[94:95], v6 offset:480
s_add_u32 s45, s45, 8448
s_cmp_eq_u32 s45, s44
s_cselect_b32 s45, s43, s45
s_waitcnt lgkmcnt(15)
v_fma_f32 v28, v28, s62, -v11
v_fma_f32 v29, v29, s62, -v11
v_fma_f32 v30, v30, s62, -v11
v_fma_f32 v31, v31, s62, -v11
v_exp_f32 v28, v28
v_exp_f32 v29, v29
v_exp_f32 v30, v30
v_exp_f32 v31, v31
s_nop 0
v_cvt_pk_bf16_f32 v24, v28, v29
v_cvt_pk_bf16_f32 v25, v30, v31
v_lshlrev_b32 v14, 16, v24
v_and_b32 v15, 0xffff0000, v24
v_lshlrev_b32 v16, 16, v25
v_and_b32 v17, 0xffff0000, v25
v_add_f32 v14, v14, v15
v_add_f32 v16, v16, v17
v_add_f32 v14, v14, v16
v_add_f32 v12, v12, v14
s_waitcnt lgkmcnt(15)
v_mfma_f32_16x16x16_bf16 v[96:99], v[64:65], v[24:25], v[96:99]
s_waitcnt lgkmcnt(14)
v_mfma_f32_16x16x16_bf16 v[100:103], v[66:67], v[24:25], v[100:103]
s_waitcnt lgkmcnt(13)
v_mfma_f32_16x16x16_bf16 v[104:107], v[68:69], v[24:25], v[104:107]
s_waitcnt lgkmcnt(12)
v_mfma_f32_16x16x16_bf16 v[108:111], v[70:71], v[24:25], v[108:111]
s_waitcnt lgkmcnt(11)
v_mfma_f32_16x16x16_bf16 v[112:115], v[72:73], v[24:25], v[112:115]
s_waitcnt lgkmcnt(10)
v_mfma_f32_16x16x16_bf16 v[116:119], v[74:75], v[24:25], v[116:119]
s_waitcnt lgkmcnt(9)
v_mfma_f32_16x16x16_bf16 v[120:123], v[76:77], v[24:25], v[120:123]
s_waitcnt lgkmcnt(8)
v_mfma_f32_16x16x16_bf16 v[124:127], v[78:79], v[24:25], v[124:127]
s_waitcnt lgkmcnt(7)
v_mfma_f32_16x16x16_bf16 v[128:131], v[80:81], v[24:25], v[128:131]
s_waitcnt lgkmcnt(6)
v_mfma_f32_16x16x16_bf16 v[132:135], v[82:83], v[24:25], v[132:135]
s_waitcnt lgkmcnt(5)
v_mfma_f32_16x16x16_bf16 v[136:139], v[84:85], v[24:25], v[136:139]
s_waitcnt lgkmcnt(4)
v_mfma_f32_16x16x16_bf16 v[140:143], v[86:87], v[24:25], v[140:143]
s_waitcnt lgkmcnt(3)
v_mfma_f32_16x16x16_bf16 v[144:147], v[88:89], v[24:25], v[144:147]
s_waitcnt lgkmcnt(2)
v_mfma_f32_16x16x16_bf16 v[148:151], v[90:91], v[24:25], v[148:151]
s_waitcnt lgkmcnt(1)
v_mfma_f32_16x16x16_bf16 v[152:155], v[92:93], v[24:25], v[152:155]
s_waitcnt lgkmcnt(0)
v_mfma_f32_16x16x16_bf16 v[156:159], v[94:95], v[24:25], v[156:159]
s_add_u32 s57, s57, 1
s_cmp_lt_u32 s57, s56
s_cbranch_scc1 L_vloop
s_cmp_eq_u32 s63, 0
s_cbranch_scc0 L_segB
s_mul_i32 s61, s28, 2080
s_add_u32 s61, s61, 151872
s_nop 15
v_mov_b32 v15, v12
v_mov_b32 v14, v15
s_nop 1
v_permlane16_swap_b32 v15, v14
s_nop 1
v_add_f32 v15, v15, v14
v_mov_b32 v14, v15
s_nop 1
v_permlane32_swap_b32 v15, v14
s_nop 1
v_add_f32 v15, v15, v14
v_mov_b32 v14, v11
v_lshlrev_b32 v6, 10, v26
v_lshl_add_u32 v6, v27, 4, v6
v_add_u32 v6, s61, v6
v_lshlrev_b32 v7, 3, v26
v_add_u32 v7, s61, v7
s_mov_b64 exec, s[92:93]
ds_write_b128 v6, v[96:99] offset:0
ds_write_b128 v6, v[100:103] offset:64
ds_write_b128 v6, v[104:107] offset:128
ds_write_b128 v6, v[108:111] offset:192
ds_write_b128 v6, v[112:115] offset:256
ds_write_b128 v6, v[116:119] offset:320
ds_write_b128 v6, v[120:123] offset:384
ds_write_b128 v6, v[124:127] offset:448
ds_write_b128 v6, v[128:131] offset:512
ds_write_b128 v6, v[132:135] offset:576
ds_write_b128 v6, v[136:139] offset:640
ds_write_b128 v6, v[140:143] offset:704
ds_write_b128 v6, v[144:147] offset:768
ds_write_b128 v6, v[148:151] offset:832
ds_write_b128 v6, v[152:155] offset:896
ds_write_b128 v6, v[156:159] offset:960
s_mov_b64 exec, 3
ds_write_b64 v7, v[14:15] offset:2048
s_mov_b64 exec, 1
v_mov_b32 v16, 1
v_mov_b32 v17, 151808
s_waitcnt lgkmcnt(0)
ds_add_u32 v17, v16
s_mov_b64 exec, -1
v_mov_b32 v96, 0
v_mov_b32 v97, 0
v_mov_b32 v98, 0
v_mov_b32 v99, 0
v_mov_b32 v100, 0
v_mov_b32 v101, 0
v_mov_b32 v102, 0
v_mov_b32 v103, 0
v_mov_b32 v104, 0
v_mov_b32 v105, 0
v_mov_b32 v106, 0
v_mov_b32 v107, 0
v_mov_b32 v108, 0
v_mov_b32 v109, 0
v_mov_b32 v110, 0
v_mov_b32 v111, 0
v_mov_b32 v112, 0
v_mov_b32 v113, 0
v_mov_b32 v114, 0
v_mov_b32 v115, 0
v_mov_b32 v116, 0
v_mov_b32 v117, 0
v_mov_b32 v118, 0
v_mov_b32 v119, 0
v_mov_b32 v120, 0
v_mov_b32 v121, 0
v_mov_b32 v122, 0
v_mov_b32 v123, 0
v_mov_b32 v124, 0
v_mov_b32 v125, 0
v_mov_b32 v126, 0
v_mov_b32 v127, 0
v_mov_b32 v128, 0
v_mov_b32 v129, 0
v_mov_b32 v130, 0
v_mov_b32 v131, 0
v_mov_b32 v132, 0
v_mov_b32 v133, 0
v_mov_b32 v134, 0
v_mov_b32 v135, 0
v_mov_b32 v136, 0
v_mov_b32 v137, 0
v_mov_b32 v138, 0
v_mov_b32 v139, 0
v_mov_b32 v140, 0
v_mov_b32 v141, 0
v_mov_b32 v142, 0
v_mov_b32 v143, 0
v_mov_b32 v144, 0
v_mov_b32 v145, 0
v_mov_b32 v146, 0
v_mov_b32 v147, 0
v_mov_b32 v148, 0
v_mov_b32 v149, 0
v_mov_b32 v150, 0
v_mov_b32 v151, 0
v_mov_b32 v152, 0
v_mov_b32 v153, 0
v_mov_b32 v154, 0
v_mov_b32 v155, 0
v_mov_b32 v156, 0
v_mov_b32 v157, 0
v_mov_b32 v158, 0
v_mov_b32 v159, 0
v_mov_b32 v10, 0xff61b1e6
v_mov_b32 v12, 0
v_and_b32 v14, 1, v26
v_lshlrev_b32 v14, 9, v14
v_lshl_add_u32 v14, v27, 4, v14
v_add_u32 v14, 150528, v14
ds_read_b128 v[32:35], v14 offset:0
ds_read_b128 v[36:39], v14 offset:64
ds_read_b128 v[40:43], v14 offset:128
ds_read_b128 v[44:47], v14 offset:192
ds_read_b128 v[48:51], v14 offset:256
ds_read_b128 v[52:55], v14 offset:320
ds_read_b128 v[56:59], v14 offset:384
ds_read_b128 v[60:63], v14 offset:448
s_waitcnt lgkmcnt(0)
s_mov_b32 s63, 1
s_mov_b32 s56, 10
s_branch L_seg
L_segB:
s_mov_b32 s57, 0
s_mov_b32 s37, 4096
s_waitcnt vmcnt(0)
v_readfirstlane_b32 s59, v8
s_nop 0
s_cmp_lt_u32 s59, 192
s_cbranch_scc0 L_sdone
s_mov_b32 s50, s59
s_lshl_b32 s38, s59, 13
s_add_u32 s38, s38, s54
s_mov_b32 s34, s38
s_mov_b32 s8, s66
s_mov_b32 s9, s67
s_add_u32 s58, s34, s37
s_add_u32 m0, s42, 0
s_nop 0
buffer_load_dwordx4 v2, s[8:11], s34 offen offset:0 nt lds
s_add_u32 m0, s42, 32
s_nop 0
buffer_load_dwordx4 v2, s[8:11], s34 offen offset:1024 nt lds
s_add_u32 m0, s42, 64
s_nop 0
buffer_load_dwordx4 v2, s[8:11], s34 offen offset:2048 nt lds
s_add_u32 m0, s42, 96
s_nop 0
buffer_load_dwordx4 v2, s[8:11], s34 offen offset:3072 nt lds
s_add_u32 m0, s42, 4224
s_nop 0
buffer_load_dwordx4 v2, s[8:11], s58 offen offset:0 nt lds
s_add_u32 m0, s42, 4256
s_nop 0
buffer_load_dwordx4 v2, s[8:11], s58 offen offset:1024 nt lds
s_add_u32 m0, s42, 4288
s_nop 0
buffer_load_dwordx4 v2, s[8:11], s58 offen offset:2048 nt lds
s_add_u32 m0, s42, 4320
s_nop 0
buffer_load_dwordx4 v2, s[8:11], s58 offen offset:3072 nt lds
s_add_u32 s42, s42, 8448
s_cmp_eq_u32 s42, s44
s_cselect_b32 s42, s43, s42
s_add_u32 s34, s34, s36
s_sub_u32 s35, s35, 1
s_mov_b32 s34, s38
s_mov_b32 s8, s68
s_mov_b32 s9, s69
s_add_u32 s58, s34, s37
s_add_u32 m0, s42, 0
s_nop 0
buffer_load_dwordx4 v2, s[8:11], s34 offen offset:0 nt lds
s_add_u32 m0, s42, 32
s_nop 0
buffer_load_dwordx4 v2, s[8:11], s34 offen offset:1024 nt lds
s_add_u32 m0, s42, 64
s_nop 0
buffer_load_dwordx4 v2, s[8:11], s34 offen offset:2048 nt lds
s_add_u32 m0, s42, 96
s_nop 0
buffer_load_dwordx4 v2, s[8:11], s34 offen offset:3072 nt lds
s_add_u32 m0, s42, 4224
s_nop 0
buffer_load_dwordx4 v2, s[8:11], s58 offen offset:0 nt lds
s_add_u32 m0, s42, 4256
s_nop 0
buffer_load_dwordx4 v2, s[8:11], s58 offen offset:1024 nt lds
s_add_u32 m0, s42, 4288
s_nop 0
buffer_load_dwordx4 v2, s[8:11], s58 offen offset:2048 nt lds
s_add_u32 m0, s42, 4320
s_nop 0
buffer_load_dwordx4 v2, s[8:11], s58 offen offset:3072 nt lds
s_add_u32 s42, s42, 8448
s_cmp_eq_u32 s42, s44
s_cselect_b32 s42, s43, s42
s_add_u32 s34, s34, s36
s_sub_u32 s35, s35, 1
s_add_u32 s49, s49, 1
L_dyn:
v_mov_b32 v13, 0xff61b1e6
s_waitcnt vmcnt(8)
s_cmp_lt_u32 s50, 96
s_cbranch_scc0 L_lazy
v_mov_b32 v8, 1
s_mov_b64 exec, 1
buffer_atomic_add v8, v9, s[12:15], s55 offen sc0 sc1
s_mov_b64 exec, -1
v_add_u32 v6, s45, v3
ds_read_b128 v[64:67], v6 offset:0
ds_read_b128 v[68:71], v6 offset:64
ds_read_b128 v[72:75], v6 offset:128
ds_read_b128 v[76:79], v6 offset:192
ds_read_b128 v[80:83], v6 offset:256
ds_read_b128 v[84:87], v6 offset:320
ds_read_b128 v[88:91], v6 offset:384
ds_read_b128 v[92:95], v6 offset:448
s_add_u32 s45, s45, 8448
s_cmp_eq_u32 s45, s44
s_cselect_b32 s45, s43, s45
s_lshl_b32 s61, s57, 6
v_add_u32 v7, s61, v5
s_waitcnt lgkmcnt(7)
v_mfma_f32_16x16x32_bf16 v[20:23], v[64:67], v[32:35], 0
s_waitcnt lgkmcnt(6)
v_mfma_f32_16x16x32_bf16 v[20:23], v[68:71], v[36:39], v[20:23]
s_waitcnt lgkmcnt(5)
v_mfma_f32_16x16x32_bf16 v[20:23], v[72:75], v[40:43], v[20:23]
s_waitcnt lgkmcnt(4)
v_mfma_f32_16x16x32_bf16 v[20:23], v[76:79], v[44:47], v[20:23]
s_waitcnt lgkmcnt(3)
v_mfma_f32_16x16x32_bf16 v[20:23], v[80:83], v[48:51], v[20:23]
s_waitcnt lgkmcnt(2)
v_mfma_f32_16x16x32_bf16 v[20:23], v[84:87], v[52:55], v[20:23]
s_waitcnt lgkmcnt(1)
v_mfma_f32_16x16x32_bf16 v[20:23], v[88:91], v[56:59], v[20:23]
s_waitcnt lgkmcnt(0)
v_mfma_f32_16x16x32_bf16 v[20:23], v[92:95], v[60:63], v[20:23]
s_nop 7
s_nop 1
v_cvt_pk_bf16_f32 v14, v20, v21
v_cvt_pk_bf16_f32 v15, v22, v23
v_lshlrev_b32 v20, 16, v14
v_and_b32 v21, 0xffff0000, v14
v_lshlrev_b32 v22, 16, v15
v_and_b32 v23, 0xffff0000, v15
v_max3_f32 v13, v20, v21, v13
v_max3_f32 v13, v22, v23, v13
s_mov_b64 exec, s[92:93]
ds_write_b128 v7, v[20:23] offset:0
s_mov_b64 exec, -1
v_mov_b32 v14, v13
s_nop 1
v_permlane16_swap_b32 v13, v14
s_nop 1
v_max_f32 v13, v13, v14
v_mov_b32 v14, v13
s_nop 1
v_permlane32_swap_b32 v13, v14
s_nop 1
v_max_f32 v13, v13, v14
v_max_f32 v13, v13, v10
v_sub_f32 v14, v10, v13
v_mul_f32 v14, s62, v14
v_exp_f32 v14, v14
v_mov_b32 v10, v13
v_mul_f32 v11, s62, v13
v_mul_f32 v12, v12, v14
v_mul_f32 v96, v96, v14
v_mul_f32 v97, v97, v14
v_mul_f32 v98, v98, v14
v_mul_f32 v99, v99, v14
v_mul_f32 v100, v100, v14
v_mul_f32 v101, v101, v14
v_mul_f32 v102, v102, v14
v_mul_f32 v103, v103, v14
v_mul_f32 v104, v104, v14
v_mul_f32 v105, v105, v14
v_mul_f32 v106, v106, v14
v_mul_f32 v107, v107, v14
v_mul_f32 v108, v108, v14
v_mul_f32 v109, v109, v14
v_mul_f32 v110, v110, v14
v_mul_f32 v111, v111, v14
v_mul_f32 v112, v112, v14
v_mul_f32 v113, v113, v14
v_mul_f32 v114, v114, v14
v_mul_f32 v115, v115, v14
v_mul_f32 v116, v116, v14
v_mul_f32 v117, v117, v14
v_mul_f32 v118, v118, v14
v_mul_f32 v119, v119, v14
v_mul_f32 v120, v120, v14
v_mul_f32 v121, v121, v14
v_mul_f32 v122, v122, v14
v_mul_f32 v123, v123, v14
v_mul_f32 v124, v124, v14
v_mul_f32 v125, v125, v14
v_mul_f32 v126, v126, v14
v_mul_f32 v127, v127, v14
v_mul_f32 v128, v128, v14
v_mul_f32 v129, v129, v14
v_mul_f32 v130, v130, v14
v_mul_f32 v131, v131, v14
v_mul_f32 v132, v132, v14
v_mul_f32 v133, v133, v14
v_mul_f32 v134, v134, v14
v_mul_f32 v135, v135, v14
v_mul_f32 v136, v136, v14
v_mul_f32 v137, v137, v14
v_mul_f32 v138, v138, v14
v_mul_f32 v139, v139, v14
v_mul_f32 v140, v140, v14
v_mul_f32 v141, v141, v14
v_mul_f32 v142, v142, v14
v_mul_f32 v143, v143, v14
v_mul_f32 v144, v144, v14
v_mul_f32 v145, v145, v14
v_mul_f32 v146, v146, v14
v_mul_f32 v147, v147, v14
v_mul_f32 v148, v148, v14
v_mul_f32 v149, v149, v14
v_mul_f32 v150, v150, v14
v_mul_f32 v151, v151, v14
v_mul_f32 v152, v152, v14
v_mul_f32 v153, v153, v14
v_mul_f32 v154, v154, v14
v_mul_f32 v155, v155, v14
v_mul_f32 v156, v156, v14
v_mul_f32 v157, v157, v14
v_mul_f32 v158, v158, v14
v_mul_f32 v159, v159, v14
s_waitcnt vmcnt(0)
v_readfirstlane_b32 s59, v8
s_mov_b32 s52, 0
s_cmp_lt_u32 s59, 192
s_cbranch_scc0 L_dyn_last
s_mov_b32 s50, s59
s_lshl_b32 s38, s59, 13
s_add_u32 s38, s38, s54
s_mov_b32 s34, s38
s_mov_b32 s8, s66
s_mov_b32 s9, s67
s_add_u32 s58, s34, s37
s_add_u32 m0, s42, 0
s_nop 0
buffer_load_dwordx4 v2, s[8:11], s34 offen offset:0 nt lds
s_add_u32 m0, s42, 32
s_nop 0
buffer_load_dwordx4 v2, s[8:11], s34 offen offset:1024 nt lds
s_add_u32 m0, s42, 64
s_nop 0
buffer_load_dwordx4 v2, s[8:11], s34 offen offset:2048 nt lds
s_add_u32 m0, s42, 96
s_nop 0
buffer_load_dwordx4 v2, s[8:11], s34 offen offset:3072 nt lds
s_add_u32 m0, s42, 4224
s_nop 0
buffer_load_dwordx4 v2, s[8:11], s58 offen offset:0 nt lds
s_add_u32 m0, s42, 4256
s_nop 0
buffer_load_dwordx4 v2, s[8:11], s58 offen offset:1024 nt lds
s_add_u32 m0, s42, 4288
s_nop 0
buffer_load_dwordx4 v2, s[8:11], s58 offen offset:2048 nt lds
s_add_u32 m0, s42, 4320
s_nop 0
buffer_load_dwordx4 v2, s[8:11], s58 offen offset:3072 nt lds
s_add_u32 s42, s42, 8448
s_cmp_eq_u32 s42, s44
s_cselect_b32 s42, s43, s42
s_add_u32 s34, s34, s36
s_sub_u32 s35, s35, 1
s_mov_b32 s34, s38
s_mov_b32 s8, s68
s_mov_b32 s9, s69
s_add_u32 s58, s34, s37
s_add_u32 m0, s42, 0
s_nop 0
buffer_load_dwordx4 v2, s[8:11], s34 offen offset:0 nt lds
s_add_u32 m0, s42, 32
s_nop 0
buffer_load_dwordx4 v2, s[8:11], s34 offen offset:1024 nt lds
s_add_u32 m0, s42, 64
s_nop 0
buffer_load_dwordx4 v2, s[8:11], s34 offen offset:2048 nt lds
s_add_u32 m0, s42, 96
s_nop 0
buffer_load_dwordx4 v2, s[8:11], s34 offen offset:3072 nt lds
s_add_u32 m0, s42, 4224
s_nop 0
buffer_load_dwordx4 v2, s[8:11], s58 offen offset:0 nt lds
s_add_u32 m0, s42, 4256
s_nop 0
buffer_load_dwordx4 v2, s[8:11], s58 offen offset:1024 nt lds
s_add_u32 m0, s42, 4288
s_nop 0
buffer_load_dwordx4 v2, s[8:11], s58 offen offset:2048 nt lds
s_add_u32 m0, s42, 4320
s_nop 0
buffer_load_dwordx4 v2, s[8:11], s58 offen offset:3072 nt lds
s_add_u32 s42, s42, 8448
s_cmp_eq_u32 s42, s44
s_cselect_b32 s42, s43, s42
s_add_u32 s34, s34, s36
s_sub_u32 s35, s35, 1
s_add_u32 s49, s49, 1
s_mov_b32 s52, 1
L_dyn_last:
s_lshl_b32 s61, s57, 6
v_add_u32 v7, s61, v5
v_add_u32 v6, s45, v4
ds_read_b128 v[28:31], v7
ds_read_b64_tr_b16 v[64:65], v6 offset:0
ds_read_b64_tr_b16 v[66:67], v6 offset:32
ds_read_b64_tr_b16 v[68:69], v6 offset:64
ds_read_b64_tr_b16 v[70:71], v6 offset:96
ds_read_b64_tr_b16 v[72:73], v6 offset:128
ds_read_b64_tr_b16 v[74:75], v6 offset:160
ds_read_b64_tr_b16 v[76:77], v6 offset:192
ds_read_b64_tr_b16 v[78:79], v6 offset:224
ds_read_b64_tr_b16 v[80:81], v6 offset:256
ds_read_b64_tr_b16 v[82:83], v6 offset:288
ds_read_b64_tr_b16 v[84:85], v6 offset:320
ds_read_b64_tr_b16 v[86:87], v6 offset:352
ds_read_b64_tr_b16 v[88:89], v6 offset:384
ds_read_b64_tr_b16 v[90:91], v6 offset:416
ds_read_b64_tr_b16 v[92:93], v6 offset:448
ds_read_b64_tr_b16 v[94:95], v6 offset:480
s_add_u32 s45, s45, 8448
s_cmp_eq_u32 s45, s44
s_cselect_b32 s45, s43, s45
s_waitcnt lgkmcnt(15)
v_fma_f32 v28, v28, s62, -v11
v_fma_f32 v29, v29, s62, -v11
v_fma_f32 v30, v30, s62, -v11
v_fma_f32 v31, v31, s62, -v11
v_exp_f32 v28, v28
v_exp_f32 v29, v29
v_exp_f32 v30, v30
v_exp_f32 v31, v31
s_nop 0
v_cvt_pk_bf16_f32 v24, v28, v29
v_cvt_pk_bf16_f32 v25, v30, v31
v_lshlrev_b32 v14, 16, v24
v_and_b32 v15, 0xffff0000, v24
v_lshlrev_b32 v16, 16, v25
v_and_b32 v17, 0xffff0000, v25
v_add_f32 v14, v14, v15
v_add_f32 v16, v16, v17
v_add_f32 v14, v14, v16
v_add_f32 v12, v12, v14
s_waitcnt lgkmcnt(15)
v_mfma_f32_16x16x16_bf16 v[96:99], v[64:65], v[24:25], v[96:99]
s_waitcnt lgkmcnt(14)
v_mfma_f32_16x16x16_bf16 v[100:103], v[66:67], v[24:25], v[100:103]
s_waitcnt lgkmcnt(13)
v_mfma_f32_16x16x16_bf16 v[104:107], v[68:69], v[24:25], v[104:107]
s_waitcnt lgkmcnt(12)
v_mfma_f32_16x16x16_bf16 v[108:111], v[70:71], v[24:25], v[108:111]
s_waitcnt lgkmcnt(11)
v_mfma_f32_16x16x16_bf16 v[112:115], v[72:73], v[24:25], v[112:115]
s_waitcnt lgkmcnt(10)
v_mfma_f32_16x16x16_bf16 v[116:119], v[74:75], v[24:25], v[116:119]
s_waitcnt lgkmcnt(9)
v_mfma_f32_16x16x16_bf16 v[120:123], v[76:77], v[24:25], v[120:123]
s_waitcnt lgkmcnt(8)
v_mfma_f32_16x16x16_bf16 v[124:127], v[78:79], v[24:25], v[124:127]
s_waitcnt lgkmcnt(7)
v_mfma_f32_16x16x16_bf16 v[128:131], v[80:81], v[24:25], v[128:131]
s_waitcnt lgkmcnt(6)
v_mfma_f32_16x16x16_bf16 v[132:135], v[82:83], v[24:25], v[132:135]
s_waitcnt lgkmcnt(5)
v_mfma_f32_16x16x16_bf16 v[136:139], v[84:85], v[24:25], v[136:139]
s_waitcnt lgkmcnt(4)
v_mfma_f32_16x16x16_bf16 v[140:143], v[86:87], v[24:25], v[140:143]
s_waitcnt lgkmcnt(3)
v_mfma_f32_16x16x16_bf16 v[144:147], v[88:89], v[24:25], v[144:147]
s_waitcnt lgkmcnt(2)
v_mfma_f32_16x16x16_bf16 v[148:151], v[90:91], v[24:25], v[148:151]
s_waitcnt lgkmcnt(1)
v_mfma_f32_16x16x16_bf16 v[152:155], v[92:93], v[24:25], v[152:155]
s_waitcnt lgkmcnt(0)
v_mfma_f32_16x16x16_bf16 v[156:159], v[94:95], v[24:25], v[156:159]
s_cmp_eq_u32 s52, 1
s_cbranch_scc1 L_dyn
s_branch L_sdone
L_lazy:
v_add_u32 v6, s45, v3
ds_read_b128 v[64:67], v6 offset:0
ds_read_b128 v[68:71], v6 offset:64
ds_read_b128 v[72:75], v6 offset:128
ds_read_b128 v[76:79], v6 offset:192
ds_read_b128 v[80:83], v6 offset:256
ds_read_b128 v[84:87], v6 offset:320
ds_read_b128 v[88:91], v6 offset:384
ds_read_b128 v[92:95], v6 offset:448
s_add_u32 s45, s45, 8448
s_cmp_eq_u32 s45, s44
s_cselect_b32 s45, s43, s45
s_lshl_b32 s61, s57, 6
v_add_u32 v7, s61, v5
s_waitcnt lgkmcnt(7)
v_mfma_f32_16x16x32_bf16 v[20:23], v[64:67], v[32:35], 0
s_waitcnt lgkmcnt(6)
v_mfma_f32_16x16x32_bf16 v[20:23], v[68:71], v[36:39], v[20:23]
s_waitcnt lgkmcnt(5)
v_mfma_f32_16x16x32_bf16 v[20:23], v[72:75], v[40:43], v[20:23]
s_waitcnt lgkmcnt(4)
v_mfma_f32_16x16x32_bf16 v[20:23], v[76:79], v[44:47], v[20:23]
s_waitcnt lgkmcnt(3)
v_mfma_f32_16x16x32_bf16 v[20:23], v[80:83], v[48:51], v[20:23]
s_waitcnt lgkmcnt(2)
v_mfma_f32_16x16x32_bf16 v[20:23], v[84:87], v[52:55], v[20:23]
s_waitcnt lgkmcnt(1)
v_mfma_f32_16x16x32_bf16 v[20:23], v[88:91], v[56:59], v[20:23]
s_waitcnt lgkmcnt(0)
v_mfma_f32_16x16x32_bf16 v[20:23], v[92:95], v[60:63], v[20:23]
s_nop 7
s_nop 1
v_cvt_pk_bf16_f32 v14, v20, v21
v_cvt_pk_bf16_f32 v15, v22, v23
v_lshlrev_b32 v20, 16, v14
v_and_b32 v21, 0xffff0000, v14
v_lshlrev_b32 v22, 16, v15
v_and_b32 v23, 0xffff0000, v15
v_max3_f32 v13, v20, v21, v13
v_max3_f32 v13, v22, v23, v13
s_mov_b64 exec, s[92:93]
ds_write_b128 v7, v[20:23] offset:0
s_mov_b64 exec, -1
v_mov_b32 v14, v13
s_nop 1
v_permlane16_swap_b32 v13, v14
s_nop 1
v_max_f32 v13, v13, v14
v_mov_b32 v14, v13
s_nop 1
v_permlane32_swap_b32 v13, v14
s_nop 1
v_max_f32 v13, v13, v14
v_max_f32 v13, v13, v10
v_sub_f32 v14, v10, v13
v_mul_f32 v14, s62, v14
v_exp_f32 v14, v14
v_mov_b32 v10, v13
v_mul_f32 v11, s62, v13
v_mul_f32 v12, v12, v14
v_mul_f32 v96, v96, v14
v_mul_f32 v97, v97, v14
v_mul_f32 v98, v98, v14
v_mul_f32 v99, v99, v14
v_mul_f32 v100, v100, v14
v_mul_f32 v101, v101, v14
v_mul_f32 v102, v102, v14
v_mul_f32 v103, v103, v14
v_mul_f32 v104, v104, v14
v_mul_f32 v105, v105, v14
v_mul_f32 v106, v106, v14
v_mul_f32 v107, v107, v14
v_mul_f32 v108, v108, v14
v_mul_f32 v109, v109, v14
v_mul_f32 v110, v110, v14
v_mul_f32 v111, v111, v14
v_mul_f32 v112, v112, v14
v_mul_f32 v113, v113, v14
v_mul_f32 v114, v114, v14
v_mul_f32 v115, v115, v14
v_mul_f32 v116, v116, v14
v_mul_f32 v117, v117, v14
v_mul_f32 v118, v118, v14
v_mul_f32 v119, v119, v14
v_mul_f32 v120, v120, v14
v_mul_f32 v121, v121, v14
v_mul_f32 v122, v122, v14
v_mul_f32 v123, v123, v14
v_mul_f32 v124, v124, v14
v_mul_f32 v125, v125, v14
v_mul_f32 v126, v126, v14
v_mul_f32 v127, v127, v14
v_mul_f32 v128, v128, v14
v_mul_f32 v129, v129, v14
v_mul_f32 v130, v130, v14
v_mul_f32 v131, v131, v14
v_mul_f32 v132, v132, v14
v_mul_f32 v133, v133, v14
v_mul_f32 v134, v134, v14
v_mul_f32 v135, v135, v14
v_mul_f32 v136, v136, v14
v_mul_f32 v137, v137, v14
v_mul_f32 v138, v138, v14
v_mul_f32 v139, v139, v14
v_mul_f32 v140, v140, v14
v_mul_f32 v141, v141, v14
v_mul_f32 v142, v142, v14
v_mul_f32 v143, v143, v14
v_mul_f32 v144, v144, v14
v_mul_f32 v145, v145, v14
v_mul_f32 v146, v146, v14
v_mul_f32 v147, v147, v14
v_mul_f32 v148, v148, v14
v_mul_f32 v149, v149, v14
v_mul_f32 v150, v150, v14
v_mul_f32 v151, v151, v14
v_mul_f32 v152, v152, v14
v_mul_f32 v153, v153, v14
v_mul_f32 v154, v154, v14
v_mul_f32 v155, v155, v14
v_mul_f32 v156, v156, v14
v_mul_f32 v157, v157, v14
v_mul_f32 v158, v158, v14
v_mul_f32 v159, v159, v14
s_waitcnt vmcnt(0)
v_mov_b32 v8, 1
s_mov_b64 exec, 1
buffer_atomic_add v8, v9, s[12:15], s55 offen sc0 sc1
s_mov_b64 exec, -1
s_lshl_b32 s61, s57, 6
v_add_u32 v7, s61, v5
v_add_u32 v6, s45, v4
ds_read_b128 v[28:31], v7
ds_read_b64_tr_b16 v[64:65], v6 offset:0
ds_read_b64_tr_b16 v[66:67], v6 offset:32
ds_read_b64_tr_b16 v[68:69], v6 offset:64
ds_read_b64_tr_b16 v[70:71], v6 offset:96
ds_read_b64_tr_b16 v[72:73], v6 offset:128
ds_read_b64_tr_b16 v[74:75], v6 offset:160
ds_read_b64_tr_b16 v[76:77], v6 offset:192
ds_read_b64_tr_b16 v[78:79], v6 offset:224
ds_read_b64_tr_b16 v[80:81], v6 offset:256
ds_read_b64_tr_b16 v[82:83], v6 offset:288
ds_read_b64_tr_b16 v[84:85], v6 offset:320
ds_read_b64_tr_b16 v[86:87], v6 offset:352
ds_read_b64_tr_b16 v[88:89], v6 offset:384
ds_read_b64_tr_b16 v[90:91], v6 offset:416
ds_read_b64_tr_b16 v[92:93], v6 offset:448
ds_read_b64_tr_b16 v[94:95], v6 offset:480
s_add_u32 s45, s45, 8448
s_cmp_eq_u32 s45, s44
s_cselect_b32 s45, s43, s45
s_waitcnt lgkmcnt(15)
v_fma_f32 v28, v28, s62, -v11
v_fma_f32 v29, v29, s62, -v11
v_fma_f32 v30, v30, s62, -v11
v_fma_f32 v31, v31, s62, -v11
v_exp_f32 v28, v28
v_exp_f32 v29, v29
v_exp_f32 v30, v30
v_exp_f32 v31, v31
s_nop 0
v_cvt_pk_bf16_f32 v24, v28, v29
v_cvt_pk_bf16_f32 v25, v30, v31
v_lshlrev_b32 v14, 16, v24
v_and_b32 v15, 0xffff0000, v24
v_lshlrev_b32 v16, 16, v25
v_and_b32 v17, 0xffff0000, v25
v_add_f32 v14, v14, v15
v_add_f32 v16, v16, v17
v_add_f32 v14, v14, v16
v_add_f32 v12, v12, v14
s_waitcnt lgkmcnt(15)
v_mfma_f32_16x16x16_bf16 v[96:99], v[64:65], v[24:25], v[96:99]
s_waitcnt lgkmcnt(14)
v_mfma_f32_16x16x16_bf16 v[100:103], v[66:67], v[24:25], v[100:103]
s_waitcnt lgkmcnt(13)
v_mfma_f32_16x16x16_bf16 v[104:107], v[68:69], v[24:25], v[104:107]
s_waitcnt lgkmcnt(12)
v_mfma_f32_16x16x16_bf16 v[108:111], v[70:71], v[24:25], v[108:111]
s_waitcnt lgkmcnt(11)
v_mfma_f32_16x16x16_bf16 v[112:115], v[72:73], v[24:25], v[112:115]
s_waitcnt lgkmcnt(10)
v_mfma_f32_16x16x16_bf16 v[116:119], v[74:75], v[24:25], v[116:119]
s_waitcnt lgkmcnt(9)
v_mfma_f32_16x16x16_bf16 v[120:123], v[76:77], v[24:25], v[120:123]
s_waitcnt lgkmcnt(8)
v_mfma_f32_16x16x16_bf16 v[124:127], v[78:79], v[24:25], v[124:127]
s_waitcnt lgkmcnt(7)
v_mfma_f32_16x16x16_bf16 v[128:131], v[80:81], v[24:25], v[128:131]
s_waitcnt lgkmcnt(6)
v_mfma_f32_16x16x16_bf16 v[132:135], v[82:83], v[24:25], v[132:135]
s_waitcnt lgkmcnt(5)
v_mfma_f32_16x16x16_bf16 v[136:139], v[84:85], v[24:25], v[136:139]
s_waitcnt lgkmcnt(4)
v_mfma_f32_16x16x16_bf16 v[140:143], v[86:87], v[24:25], v[140:143]
s_waitcnt lgkmcnt(3)
v_mfma_f32_16x16x16_bf16 v[144:147], v[88:89], v[24:25], v[144:147]
s_waitcnt lgkmcnt(2)
v_mfma_f32_16x16x16_bf16 v[148:151], v[90:91], v[24:25], v[148:151]
s_waitcnt lgkmcnt(1)
v_mfma_f32_16x16x16_bf16 v[152:155], v[92:93], v[24:25], v[152:155]
s_waitcnt lgkmcnt(0)
v_mfma_f32_16x16x16_bf16 v[156:159], v[94:95], v[24:25], v[156:159]
s_waitcnt vmcnt(0)
v_readfirstlane_b32 s59, v8
s_nop 0
s_cmp_lt_u32 s59, 192
s_cbranch_scc0 L_sdone
s_mov_b32 s50, s59
s_lshl_b32 s38, s59, 13
s_add_u32 s38, s38, s54
s_mov_b32 s34, s38
s_mov_b32 s8, s66
s_mov_b32 s9, s67
s_add_u32 s58, s34, s37
s_add_u32 m0, s42, 0
s_nop 0
buffer_load_dwordx4 v2, s[8:11], s34 offen offset:0 nt lds
s_add_u32 m0, s42, 32
s_nop 0
buffer_load_dwordx4 v2, s[8:11], s34 offen offset:1024 nt lds
s_add_u32 m0, s42, 64
s_nop 0
buffer_load_dwordx4 v2, s[8:11], s34 offen offset:2048 nt lds
s_add_u32 m0, s42, 96
s_nop 0
buffer_load_dwordx4 v2, s[8:11], s34 offen offset:3072 nt lds
s_add_u32 m0, s42, 4224
s_nop 0
buffer_load_dwordx4 v2, s[8:11], s58 offen offset:0 nt lds
s_add_u32 m0, s42, 4256
s_nop 0
buffer_load_dwordx4 v2, s[8:11], s58 offen offset:1024 nt lds
s_add_u32 m0, s42, 4288
s_nop 0
buffer_load_dwordx4 v2, s[8:11], s58 offen offset:2048 nt lds
s_add_u32 m0, s42, 4320
s_nop 0
buffer_load_dwordx4 v2, s[8:11], s58 offen offset:3072 nt lds
s_add_u32 s42, s42, 8448
s_cmp_eq_u32 s42, s44
s_cselect_b32 s42, s43, s42
s_add_u32 s34, s34, s36
s_sub_u32 s35, s35, 1
s_mov_b32 s34, s38
s_mov_b32 s8, s68
s_mov_b32 s9, s69
s_add_u32 s58, s34, s37
s_add_u32 m0, s42, 0
s_nop 0
buffer_load_dwordx4 v2, s[8:11], s34 offen offset:0 nt lds
s_add_u32 m0, s42, 32
s_nop 0
buffer_load_dwordx4 v2, s[8:11], s34 offen offset:1024 nt lds
s_add_u32 m0, s42, 64
s_nop 0
buffer_load_dwordx4 v2, s[8:11], s34 offen offset:2048 nt lds
s_add_u32 m0, s42, 96
s_nop 0
buffer_load_dwordx4 v2, s[8:11], s34 offen offset:3072 nt lds
s_add_u32 m0, s42, 4224
s_nop 0
buffer_load_dwordx4 v2, s[8:11], s58 offen offset:0 nt lds
s_add_u32 m0, s42, 4256
s_nop 0
buffer_load_dwordx4 v2, s[8:11], s58 offen offset:1024 nt lds
s_add_u32 m0, s42, 4288
s_nop 0
buffer_load_dwordx4 v2, s[8:11], s58 offen offset:2048 nt lds
s_add_u32 m0, s42, 4320
s_nop 0
buffer_load_dwordx4 v2, s[8:11], s58 offen offset:3072 nt lds
s_add_u32 s42, s42, 8448
s_cmp_eq_u32 s42, s44
s_cselect_b32 s42, s43, s42
s_add_u32 s34, s34, s36
s_sub_u32 s35, s35, 1
s_add_u32 s49, s49, 1
s_branch L_dyn
L_sdone:
s_add_u32 s61, s43, 16896
s_nop 15
v_mov_b32 v15, v12
v_mov_b32 v14, v15
s_nop 1
v_permlane16_swap_b32 v15, v14
s_nop 1
v_add_f32 v15, v15, v14
v_mov_b32 v14, v15
s_nop 1
v_permlane32_swap_b32 v15, v14
s_nop 1
v_add_f32 v15, v15, v14
v_mov_b32 v14, v11
v_lshlrev_b32 v6, 10, v26
v_lshl_add_u32 v6, v27, 4, v6
v_add_u32 v6, s61, v6
v_lshlrev_b32 v7, 3, v26
v_add_u32 v7, s61, v7
s_mov_b64 exec, s[92:93]
ds_write_b128 v6, v[96:99] offset:0
ds_write_b128 v6, v[100:103] offset:64
ds_write_b128 v6, v[104:107] offset:128
ds_write_b128 v6, v[108:111] offset:192
ds_write_b128 v6, v[112:115] offset:256
ds_write_b128 v6, v[116:119] offset:320
ds_write_b128 v6, v[120:123] offset:384
ds_write_b128 v6, v[124:127] offset:448
ds_write_b128 v6, v[128:131] offset:512
ds_write_b128 v6, v[132:135] offset:576
ds_write_b128 v6, v[136:139] offset:640
ds_write_b128 v6, v[140:143] offset:704
ds_write_b128 v6, v[144:147] offset:768
ds_write_b128 v6, v[148:151] offset:832
ds_write_b128 v6, v[152:155] offset:896
ds_write_b128 v6, v[156:159] offset:960
s_mov_b64 exec, 3
ds_write_b64 v7, v[14:15] offset:2048
s_mov_b64 exec, 1
v_mov_b32 v16, 1
v_mov_b32 v17, 151812
s_waitcnt lgkmcnt(0)
ds_add_u32 v17, v16
s_mov_b64 exec, -1
v_mul_u32_u24 v18, 896, v27
v_lshl_add_u32 v18, v26, 4, v18
s_lshl_b32 s58, s31, 3
s_add_u32 s58, s58, s30
s_mul_i32 s59, s58, 57344
s_mul_i32 s60, s28, 224
s_add_u32 s59, s59, s60
s_add_u32 m0, s43, 0
s_add_u32 s60, s59, 0
buffer_load_dwordx4 v18, s[16:19], s60 offen nt lds
s_add_u32 m0, s43, 1056
s_add_u32 s60, s59, 3584
buffer_load_dwordx4 v18, s[16:19], s60 offen nt lds
s_add_u32 m0, s43, 2112
s_add_u32 s60, s59, 7168
buffer_load_dwordx4 v18, s[16:19], s60 offen nt lds
s_add_u32 m0, s43, 3168
s_add_u32 s60, s59, 10752
buffer_load_dwordx4 v18, s[16:19], s60 offen nt lds
s_add_u32 m0, s43, 4224
s_add_u32 s60, s59, 14336
buffer_load_dwordx4 v18, s[16:19], s60 offen nt lds
s_add_u32 m0, s43, 5280
s_add_u32 s60, s59, 17920
buffer_load_dwordx4 v18, s[16:19], s60 offen nt lds
s_add_u32 m0, s43, 6336
s_add_u32 s60, s59, 21504
buffer_load_dwordx4 v18, s[16:19], s60 offen nt lds
s_add_u32 m0, s43, 7392
s_add_u32 s60, s59, 25088
buffer_load_dwordx4 v18, s[16:19], s60 offen nt lds
s_add_u32 m0, s43, 8448
s_add_u32 s60, s59, 28672
buffer_load_dwordx4 v18, s[16:19], s60 offen nt lds
s_add_u32 m0, s43, 9504
s_add_u32 s60, s59, 32256
buffer_load_dwordx4 v18, s[16:19], s60 offen nt lds
s_add_u32 m0, s43, 10560
s_add_u32 s60, s59, 35840
buffer_load_dwordx4 v18, s[16:19], s60 offen nt lds
s_add_u32 m0, s43, 11616
s_add_u32 s60, s59, 39424
buffer_load_dwordx4 v18, s[16:19], s60 offen nt lds
s_add_u32 m0, s43, 12672
s_add_u32 s60, s59, 43008
buffer_load_dwordx4 v18, s[16:19], s60 offen nt lds
s_add_u32 m0, s43, 13728
s_add_u32 s60, s59, 46592
buffer_load_dwordx4 v18, s[16:19], s60 offen nt lds
s_add_u32 m0, s43, 14784
s_add_u32 s60, s59, 50176
buffer_load_dwordx4 v18, s[16:19], s60 offen nt lds
s_add_u32 m0, s43, 15840
s_add_u32 s60, s59, 53760
buffer_load_dwordx4 v18, s[16:19], s60 offen nt lds
v_mul_u32_u24 v6, 2112, v27
v_lshrrev_b32 v14, 2, v26
v_lshl_add_u32 v6, v14, 8, v6
v_and_b32 v14, 3, v26
v_lshl_add_u32 v6, v14, 3, v6
v_add_u32 v6, s43, v6
v_and_b32 v14, 1, v26
v_lshlrev_b32 v7, 7, v14
v_lshl_add_u32 v7, v27, 4, v7
v_add_u32 v7, 151552, v7
v_lshlrev_b32 v19, 19, v26
v_lshl_add_u32 v19, v27, 4, v19
s_lshl_b32 s59, s32, 5
s_mul_i32 s60, s28, 7
s_add_u32 s59, s59, s60
s_lshl_b32 s59, s59, 6
s_add_u32 s59, s59, s58
s_lshl_b32 s59, s59, 6
s_add_u32 s59, s59, 1310720
s_waitcnt vmcnt(0)
ds_read_b64_tr_b16 v[96:97], v6 offset:0
ds_read_b64_tr_b16 v[98:99], v6 offset:1056
ds_read_b64_tr_b16 v[100:101], v6 offset:8448
ds_read_b64_tr_b16 v[102:103], v6 offset:9504
ds_read_b64_tr_b16 v[104:105], v6 offset:32
ds_read_b64_tr_b16 v[106:107], v6 offset:1088
ds_read_b64_tr_b16 v[108:109], v6 offset:8480
ds_read_b64_tr_b16 v[110:111], v6 offset:9536
ds_read_b64_tr_b16 v[112:113], v6 offset:64
ds_read_b64_tr_b16 v[114:115], v6 offset:1120
ds_read_b64_tr_b16 v[116:117], v6 offset:8512
ds_read_b64_tr_b16 v[118:119], v6 offset:9568
ds_read_b64_tr_b16 v[120:121], v6 offset:96
ds_read_b64_tr_b16 v[122:123], v6 offset:1152
ds_read_b64_tr_b16 v[124:125], v6 offset:8544
ds_read_b64_tr_b16 v[126:127], v6 offset:9600
ds_read_b64_tr_b16 v[128:129], v6 offset:128
ds_read_b64_tr_b16 v[130:131], v6 offset:1184
ds_read_b64_tr_b16 v[132:133], v6 offset:8576
ds_read_b64_tr_b16 v[134:135], v6 offset:9632
ds_read_b64_tr_b16 v[136:137], v6 offset:160
ds_read_b64_tr_b16 v[138:139], v6 offset:1216
ds_read_b64_tr_b16 v[140:141], v6 offset:8608
ds_read_b64_tr_b16 v[142:143], v6 offset:9664
ds_read_b64_tr_b16 v[144:145], v6 offset:192
ds_read_b64_tr_b16 v[146:147], v6 offset:1248
ds_read_b64_tr_b16 v[148:149], v6 offset:8640
ds_read_b64_tr_b16 v[150:151], v6 offset:9696
s_waitcnt lgkmcnt(0)
s_barrier
ds_read_b128 v[32:35], v7
ds_read_b128 v[36:39], v7 offset:64
s_waitcnt lgkmcnt(0)
v_mfma_f32_16x16x32_bf16 v[64:67], v[96:99], v[32:35], 0
v_mfma_f32_16x16x32_bf16 v[64:67], v[100:103], v[36:39], v[64:67]
v_mfma_f32_16x16x32_bf16 v[68:71], v[104:107], v[32:35], 0
v_mfma_f32_16x16x32_bf16 v[68:71], v[108:111], v[36:39], v[68:71]
v_mfma_f32_16x16x32_bf16 v[72:75], v[112:115], v[32:35], 0
v_mfma_f32_16x16x32_bf16 v[72:75], v[116:119], v[36:39], v[72:75]
v_mfma_f32_16x16x32_bf16 v[76:79], v[120:123], v[32:35], 0
v_mfma_f32_16x16x32_bf16 v[76:79], v[124:127], v[36:39], v[76:79]
v_mfma_f32_16x16x32_bf16 v[80:83], v[128:131], v[32:35], 0
v_mfma_f32_16x16x32_bf16 v[80:83], v[132:135], v[36:39], v[80:83]
v_mfma_f32_16x16x32_bf16 v[84:87], v[136:139], v[32:35], 0
v_mfma_f32_16x16x32_bf16 v[84:87], v[140:143], v[36:39], v[84:87]
v_mfma_f32_16x16x32_bf16 v[88:91], v[144:147], v[32:35], 0
v_mfma_f32_16x16x32_bf16 v[88:91], v[148:151], v[36:39], v[88:91]
s_nop 7
s_nop 3
v_min_u32 v64, 0xfffffffe, v64
v_min_u32 v65, 0xfffffffe, v65
v_min_u32 v66, 0xfffffffe, v66
v_min_u32 v67, 0xfffffffe, v67
v_min_u32 v68, 0xfffffffe, v68
v_min_u32 v69, 0xfffffffe, v69
v_min_u32 v70, 0xfffffffe, v70
v_min_u32 v71, 0xfffffffe, v71
v_min_u32 v72, 0xfffffffe, v72
v_min_u32 v73, 0xfffffffe, v73
v_min_u32 v74, 0xfffffffe, v74
v_min_u32 v75, 0xfffffffe, v75
v_min_u32 v76, 0xfffffffe, v76
v_min_u32 v77, 0xfffffffe, v77
v_min_u32 v78, 0xfffffffe, v78
v_min_u32 v79, 0xfffffffe, v79
v_min_u32 v80, 0xfffffffe, v80
v_min_u32 v81, 0xfffffffe, v81
v_min_u32 v82, 0xfffffffe, v82
v_min_u32 v83, 0xfffffffe, v83
v_min_u32 v84, 0xfffffffe, v84
v_min_u32 v85, 0xfffffffe, v85
v_min_u32 v86, 0xfffffffe, v86
v_min_u32 v87, 0xfffffffe, v87
v_min_u32 v88, 0xfffffffe, v88
v_min_u32 v89, 0xfffffffe, v89
v_min_u32 v90, 0xfffffffe, v90
v_min_u32 v91, 0xfffffffe, v91
s_mov_b64 exec, s[92:93]
s_add_u32 s60, s59, 0
buffer_store_dwordx4 v[64:67], v19, s[12:15], s60 offen sc1
s_add_u32 s60, s59, 4096
buffer_store_dwordx4 v[68:71], v19, s[12:15], s60 offen sc1
s_add_u32 s60, s59, 8192
buffer_store_dwordx4 v[72:75], v19, s[12:15], s60 offen sc1
s_add_u32 s60, s59, 12288
buffer_store_dwordx4 v[76:79], v19, s[12:15], s60 offen sc1
s_add_u32 s60, s59, 16384
buffer_store_dwordx4 v[80:83], v19, s[12:15], s60 offen sc1
s_add_u32 s60, s59, 20480
buffer_store_dwordx4 v[84:87], v19, s[12:15], s60 offen sc1
s_add_u32 s60, s59, 24576
buffer_store_dwordx4 v[88:91], v19, s[12:15], s60 offen sc1
s_mov_b64 exec, -1
s_endpgm
L_helper:
s_setprio 3
s_mov_b32 s16, s70
s_and_b32 s17, s71, 0xffff
s_mov_b32 s18, 3670016
s_mov_b32 s19, 0x00020000
s_mov_b32 s20, s76
s_and_b32 s21, s77, 0xffff
s_mov_b32 s22, 256
s_mov_b32 s23, 0x00020000
s_mov_b32 s24, s64
s_and_b32 s25, s65, 0xffff
s_mov_b32 s26, 7168
s_mov_b32 s27, 0x00020000
s_cmp_lg_u32 s2, 0
s_cbranch_scc1 L_h_nowr
s_memrealtime s[96:97]
s_waitcnt lgkmcnt(0)
s_or_b32 s96, s96, 1
v_mov_b32 v112, s96
v_mov_b32 v113, s97
v_mov_b32 v114, 0
v_mov_b32 v115, 0
s_mov_b64 exec, 1
buffer_atomic_cmpswap_x2 v[112:115], v9, s[20:23], 0 offen sc1
s_mov_b64 exec, -1
L_h_nowr:
s_lshl_b32 s58, s31, 5
s_lshl_b32 s59, s30, 2
s_add_u32 s58, s58, s59
s_add_u32 s58, s58, s32
s_lshl_b32 s34, s58, 5
v_lshrrev_b32 v104, 1, v1
v_lshlrev_b32 v104, 13, v104
v_and_b32 v105, 1, v1
v_lshl_add_u32 v104, v105, 4, v104
s_mov_b32 m0, 135168
s_add_u32 s59, s34, 0
buffer_load_dwordx4 v104, s[16:19], s59 offen nt lds
s_mov_b32 m0, 136192
s_add_u32 s59, s34, 262144
buffer_load_dwordx4 v104, s[16:19], s59 offen nt lds
s_mov_b32 m0, 137216
s_add_u32 s59, s34, 524288
buffer_load_dwordx4 v104, s[16:19], s59 offen nt lds
s_mov_b32 m0, 138240
s_add_u32 s59, s34, 786432
buffer_load_dwordx4 v104, s[16:19], s59 offen nt lds
s_mov_b32 m0, 139264
s_add_u32 s59, s34, 1048576
buffer_load_dwordx4 v104, s[16:19], s59 offen nt lds
s_mov_b32 m0, 140288
s_add_u32 s59, s34, 1310720
buffer_load_dwordx4 v104, s[16:19], s59 offen nt lds
s_mov_b32 m0, 141312
s_add_u32 s59, s34, 1572864
buffer_load_dwordx4 v104, s[16:19], s59 offen nt lds
s_mov_b32 m0, 142336
s_add_u32 s59, s34, 1835008
buffer_load_dwordx4 v104, s[16:19], s59 offen nt lds
s_mov_b32 m0, 143360
s_add_u32 s59, s34, 2097152
buffer_load_dwordx4 v104, s[16:19], s59 offen nt lds
s_mov_b32 m0, 144384
s_add_u32 s59, s34, 2359296
buffer_load_dwordx4 v104, s[16:19], s59 offen nt lds
s_mov_b32 m0, 145408
s_add_u32 s59, s34, 2621440
buffer_load_dwordx4 v104, s[16:19], s59 offen nt lds
s_mov_b32 m0, 146432
s_add_u32 s59, s34, 2883584
buffer_load_dwordx4 v104, s[16:19], s59 offen nt lds
s_mov_b32 m0, 147456
s_add_u32 s59, s34, 3145728
buffer_load_dwordx4 v104, s[16:19], s59 offen nt lds
s_mov_b32 m0, 148480
s_add_u32 s59, s34, 3407872
buffer_load_dwordx4 v104, s[16:19], s59 offen nt lds
v_and_b32 v105, 7, v26
v_mul_u32_u24 v105, 896, v105
v_lshl_add_u32 v105, v27, 4, v105
buffer_load_dwordx4 v[32:35], v105, s[24:27], 0 offen offset:0
buffer_load_dwordx4 v[36:39], v105, s[24:27], 0 offen offset:64
buffer_load_dwordx4 v[40:43], v105, s[24:27], 0 offen offset:128
buffer_load_dwordx4 v[44:47], v105, s[24:27], 0 offen offset:192
buffer_load_dwordx4 v[48:51], v105, s[24:27], 0 offen offset:256
buffer_load_dwordx4 v[52:55], v105, s[24:27], 0 offen offset:320
buffer_load_dwordx4 v[56:59], v105, s[24:27], 0 offen offset:384
buffer_load_dwordx4 v[60:63], v105, s[24:27], 0 offen offset:448
buffer_load_dwordx4 v[64:67], v105, s[24:27], 0 offen offset:512
buffer_load_dwordx4 v[68:71], v105, s[24:27], 0 offen offset:576
buffer_load_dwordx4 v[72:75], v105, s[24:27], 0 offen offset:640
buffer_load_dwordx4 v[76:79], v105, s[24:27], 0 offen offset:704
buffer_load_dwordx4 v[80:83], v105, s[24:27], 0 offen offset:768
buffer_load_dwordx4 v[84:87], v105, s[24:27], 0 offen offset:832
s_barrier
v_mov_b32 v112, -1
v_mov_b32 v113, -1
v_mov_b32 v114, -1
v_mov_b32 v115, -1
s_lshl_b32 s58, s33, 3
s_add_u32 s58, s58, s30
s_lshl_b32 s38, s58, 11
s_add_u32 s38, s38, 262144
s_add_u32 s39, s38, 524288
s_lshl_b32 s36, s58, 6
s_add_u32 s36, s36, 131072
s_add_u32 s37, s36, 16384
s_lshl_b32 s54, s2, 12
s_add_u32 s54, s54, 1310720
buffer_store_dwordx4 v[112:115], v2, s[12:15], s38 offen offset:0 sc1
buffer_store_dwordx4 v[112:115], v2, s[12:15], s38 offen offset:1024 sc1
buffer_store_dwordx4 v[112:115], v2, s[12:15], s39 offen offset:0 sc1
buffer_store_dwordx4 v[112:115], v2, s[12:15], s39 offen offset:1024 sc1
s_and_b32 s59, s2, 31
s_cmp_ge_u32 s59, 28
s_cbranch_scc1 L_h_nofin
buffer_store_dwordx4 v[112:115], v2, s[12:15], s54 offen offset:0 sc1
buffer_store_dwordx4 v[112:115], v2, s[12:15], s54 offen offset:1024 sc1
buffer_store_dwordx4 v[112:115], v2, s[12:15], s54 offen offset:2048 sc1
buffer_store_dwordx4 v[112:115], v2, s[12:15], s54 offen offset:3072 sc1
L_h_nofin:
s_mov_b64 exec, 15
buffer_store_dwordx4 v[112:115], v2, s[12:15], s36 offen sc1
buffer_store_dwordx4 v[112:115], v2, s[12:15], s37 offen sc1
s_mov_b64 exec, 1
s_cmp_eq_u32 s30, 0
s_cbranch_scc0 L_h_nocnt
s_lshl_b32 s59, s29, 8
s_add_u32 s59, s59, 65536
buffer_store_dword v9, v9, s[12:15], s59 offen sc1
L_h_nocnt:
v_mov_b32 v106, 151808
v_mov_b32 v108, 0
v_mov_b32 v109, 0
ds_write_b64 v106, v[108:109]
ds_write_b64 v106, v[108:109] offset:8
s_mov_b64 exec, -1
v_lshrrev_b32 v106, 2, v26
v_lshl_add_u32 v106, v27, 3, v106
v_lshlrev_b32 v106, 5, v106
v_and_b32 v107, 3, v26
v_lshl_add_u32 v106, v107, 3, v106
v_add_u32 v106, 135168, v106
v_lshlrev_b32 v107, 14, v26
v_lshl_add_u32 v107, v27, 4, v107
s_lshl_b32 s34, s34, 1
s_add_u32 s34, s34, 2621440
buffer_load_dwordx2 v[116:117], v9, s[20:23], 0 offen sc1
s_waitcnt vmcnt(0)
s_mov_b64 exec, 1
v_mov_b32 v108, 1
s_lshl_b32 s55, s31, 4
buffer_atomic_add v108, v9, s[20:23], s55 offen offset:128 sc1
s_mov_b64 exec, -1
ds_read_b64_tr_b16 v[120:121], v106 offset:0
ds_read_b64_tr_b16 v[122:123], v106 offset:128
s_waitcnt lgkmcnt(0)
v_mfma_f32_16x16x32_bf16 v[100:103], v[120:123], v[32:35], 0
ds_read_b64_tr_b16 v[124:125], v106 offset:1024
ds_read_b64_tr_b16 v[126:127], v106 offset:1152
s_waitcnt lgkmcnt(0)
v_mfma_f32_16x16x32_bf16 v[100:103], v[124:127], v[36:39], v[100:103]
ds_read_b64_tr_b16 v[128:129], v106 offset:2048
ds_read_b64_tr_b16 v[130:131], v106 offset:2176
s_waitcnt lgkmcnt(0)
v_mfma_f32_16x16x32_bf16 v[100:103], v[128:131], v[40:43], v[100:103]
ds_read_b64_tr_b16 v[132:133], v106 offset:3072
ds_read_b64_tr_b16 v[134:135], v106 offset:3200
s_waitcnt lgkmcnt(0)
v_mfma_f32_16x16x32_bf16 v[100:103], v[132:135], v[44:47], v[100:103]
ds_read_b64_tr_b16 v[120:121], v106 offset:4096
ds_read_b64_tr_b16 v[122:123], v106 offset:4224
s_waitcnt lgkmcnt(0)
v_mfma_f32_16x16x32_bf16 v[100:103], v[120:123], v[48:51], v[100:103]
ds_read_b64_tr_b16 v[124:125], v106 offset:5120
ds_read_b64_tr_b16 v[126:127], v106 offset:5248
s_waitcnt lgkmcnt(0)
v_mfma_f32_16x16x32_bf16 v[100:103], v[124:127], v[52:55], v[100:103]
ds_read_b64_tr_b16 v[128:129], v106 offset:6144
ds_read_b64_tr_b16 v[130:131], v106 offset:6272
s_waitcnt lgkmcnt(0)
v_mfma_f32_16x16x32_bf16 v[100:103], v[128:131], v[56:59], v[100:103]
ds_read_b64_tr_b16 v[132:133], v106 offset:7168
ds_read_b64_tr_b16 v[134:135], v106 offset:7296
s_waitcnt lgkmcnt(0)
v_mfma_f32_16x16x32_bf16 v[100:103], v[132:135], v[60:63], v[100:103]
ds_read_b64_tr_b16 v[120:121], v106 offset:8192
ds_read_b64_tr_b16 v[122:123], v106 offset:8320
s_waitcnt lgkmcnt(0)
v_mfma_f32_16x16x32_bf16 v[100:103], v[120:123], v[64:67], v[100:103]
ds_read_b64_tr_b16 v[124:125], v106 offset:9216
ds_read_b64_tr_b16 v[126:127], v106 offset:9344
s_waitcnt lgkmcnt(0)
v_mfma_f32_16x16x32_bf16 v[100:103], v[124:127], v[68:71], v[100:103]
ds_read_b64_tr_b16 v[128:129], v106 offset:10240
ds_read_b64_tr_b16 v[130:131], v106 offset:10368
s_waitcnt lgkmcnt(0)
v_mfma_f32_16x16x32_bf16 v[100:103], v[128:131], v[72:75], v[100:103]
ds_read_b64_tr_b16 v[132:133], v106 offset:11264
ds_read_b64_tr_b16 v[134:135], v106 offset:11392
s_waitcnt lgkmcnt(0)
v_mfma_f32_16x16x32_bf16 v[100:103], v[132:135], v[76:79], v[100:103]
ds_read_b64_tr_b16 v[120:121], v106 offset:12288
ds_read_b64_tr_b16 v[122:123], v106 offset:12416
s_waitcnt lgkmcnt(0)
v_mfma_f32_16x16x32_bf16 v[100:103], v[120:123], v[80:83], v[100:103]
ds_read_b64_tr_b16 v[124:125], v106 offset:13312
ds_read_b64_tr_b16 v[126:127], v106 offset:13440
s_waitcnt lgkmcnt(0)
v_mfma_f32_16x16x32_bf16 v[100:103], v[124:127], v[84:87], v[100:103]
s_mov_b32 s94, 0
L_h_nonce:
v_readfirstlane_b32 s96, v116
v_readfirstlane_b32 s97, v117
s_add_u32 s94, s94, 1
s_cmp_lg_u32 s96, 0
s_cbranch_scc1 L_h_gotn
buffer_load_dwordx2 v[116:117], v9, s[20:23], 0 offen sc1
s_waitcnt vmcnt(0)
s_cmp_lt_u32 s94, 65536
s_cbranch_scc1 L_h_nonce
L_h_gotn:
s_nop 7
v_cvt_pk_bf16_f32 v112, v100, v101
v_cvt_pk_bf16_f32 v113, v102, v103
v_mov_b32 v114, s96
v_mov_b32 v115, s97
s_mov_b32 exec_lo, 0x00ff00ff
s_mov_b32 exec_hi, 0x00ff00ff
buffer_store_dwordx4 v[112:115], v107, s[12:15], s34 offen sc1
s_mov_b64 exec, -1
s_lshl_b32 s59, s32, 14
s_lshl_b32 s60, s31, 11
s_add_u32 s59, s59, s60
s_add_u32 s59, s59, 2621440
s_add_u32 s60, s59, 65536
s_mov_b32 s94, 0
L_h_pollq:
buffer_load_dwordx4 v[120:123], v2, s[12:15], s59 offen sc1
buffer_load_dwordx4 v[124:127], v2, s[12:15], s59 offen offset:1024 sc1
buffer_load_dwordx4 v[128:131], v2, s[12:15], s60 offen sc1
buffer_load_dwordx4 v[132:135], v2, s[12:15], s60 offen offset:1024 sc1
s_waitcnt vmcnt(0)
v_xor_b32 v122, s96, v122
v_xor_b32 v123, s97, v123
v_xor_b32 v126, s96, v126
v_xor_b32 v127, s97, v127
v_xor_b32 v130, s96, v130
v_xor_b32 v131, s97, v131
v_xor_b32 v134, s96, v134
v_xor_b32 v135, s97, v135
v_or3_b32 v108, v122, v123, v126
v_or3_b32 v108, v127, v130, v108
v_or3_b32 v108, v131, v134, v108
v_or_b32 v108, v135, v108
v_cmp_ne_u32 vcc, 0, v108
s_add_u32 s94, s94, 1
s_cmp_eq_u64 vcc, 0
s_cbranch_scc1 L_h_gotq
s_sleep 4
s_cmp_lt_u32 s94, 65536
s_cbranch_scc1 L_h_pollq
L_h_gotq:
v_lshlrev_b32 v104, 3, v1
v_add_u32 v104, 149504, v104
ds_write_b64 v104, v[120:121] offset:0
ds_write_b64 v104, v[124:125] offset:512
ds_write_b64 v104, v[128:129] offset:1024
ds_write_b64 v104, v[132:133] offset:1536
s_waitcnt lgkmcnt(0)
s_barrier
s_mov_b32 s24, s74
s_and_b32 s25, s75, 0xffff
s_mov_b32 s26, 7168
s_mov_b32 s27, 0x00020000
v_lshlrev_b32 v104, 5, v1
v_lshrrev_b32 v105, 5, v1
v_lshlrev_b32 v105, 3, v105
v_lshrrev_b32 v106, 3, v1
v_lshlrev_b32 v107, 6, v106
v_lshlrev_b32 v106, 11, v106
v_and_b32 v108, 7, v1
v_lshl_add_u32 v106, v108, 5, v106
v_mov_b32 v109, 151808
v_lshlrev_b32 v162, 4, v1
s_mov_b32 s94, 0
L_h_pollall:
s_sleep 32
s_mov_b64 exec, 0xff
buffer_load_dword v108, v162, s[20:23], 0 offen offset:128 sc1
s_waitcnt vmcnt(0)
v_cmp_gt_u32 vcc, 32, v108
s_mov_b64 exec, -1
s_add_u32 s94, s94, 1
s_cmp_eq_u64 vcc, 0
s_cbranch_scc1 L_h_allok
s_cmp_lt_u32 s94, 65536
s_cbranch_scc1 L_h_pollall
L_h_allok:
v_mov_b32 v108, 1
ds_write_b32 v109, v108 offset:8
s_mov_b32 s94, 0
L_hc_19_poll:
ds_read_b32 v108, v109 offset:0
s_waitcnt lgkmcnt(0)
v_readfirstlane_b32 s59, v108
s_nop 1
s_cmp_eq_u32 s59, 4
s_cbranch_scc1 L_hc_19_go
s_sleep 4
s_add_u32 s94, s94, 1
s_cmp_lt_u32 s94, 262144
s_cbranch_scc1 L_hc_19_poll
L_hc_19_go:
v_add_u32 v160, 151872, v104
v_add_u32 v161, 151872, v105
ds_read_b128 v[120:123], v160
ds_read_b128 v[124:127], v160 offset:16
ds_read_b64 v[152:153], v161 offset:2048
v_add_u32 v160, 153952, v104
v_add_u32 v161, 153952, v105
ds_read_b128 v[128:131], v160
ds_read_b128 v[132:135], v160 offset:16
ds_read_b64 v[154:155], v161 offset:2048
v_add_u32 v160, 156032, v104
v_add_u32 v161, 156032, v105
ds_read_b128 v[136:139], v160
ds_read_b128 v[140:143], v160 offset:16
ds_read_b64 v[156:157], v161 offset:2048
v_add_u32 v160, 158112, v104
v_add_u32 v161, 158112, v105
ds_read_b128 v[144:147], v160
ds_read_b128 v[148:151], v160 offset:16
ds_read_b64 v[158:159], v161 offset:2048
s_waitcnt lgkmcnt(0)
v_max_f32 v116, v152, v154
v_max3_f32 v116, v156, v158, v116
v_sub_f32 v152, v152, v116
v_sub_f32 v154, v154, v116
v_sub_f32 v156, v156, v116
v_sub_f32 v158, v158, v116
v_exp_f32 v152, v152
v_exp_f32 v154, v154
v_exp_f32 v156, v156
v_exp_f32 v158, v158
s_nop 0
v_mul_f32 v117, v152, v153
v_fmac_f32 v117, v154, v155
v_fmac_f32 v117, v156, v157
v_fmac_f32 v117, v158, v159
v_mul_f32 v120, v120, v152
v_fmac_f32 v120, v128, v154
v_fmac_f32 v120, v136, v156
v_fmac_f32 v120, v144, v158
v_min_u32 v120, 0xfffffffe, v120
v_mul_f32 v121, v121, v152
v_fmac_f32 v121, v129, v154
v_fmac_f32 v121, v137, v156
v_fmac_f32 v121, v145, v158
v_min_u32 v121, 0xfffffffe, v121
v_mul_f32 v122, v122, v152
v_fmac_f32 v122, v130, v154
v_fmac_f32 v122, v138, v156
v_fmac_f32 v122, v146, v158
v_min_u32 v122, 0xfffffffe, v122
v_mul_f32 v123, v123, v152
v_fmac_f32 v123, v131, v154
v_fmac_f32 v123, v139, v156
v_fmac_f32 v123, v147, v158
v_min_u32 v123, 0xfffffffe, v123
v_mul_f32 v124, v124, v152
v_fmac_f32 v124, v132, v154
v_fmac_f32 v124, v140, v156
v_fmac_f32 v124, v148, v158
v_min_u32 v124, 0xfffffffe, v124
v_mul_f32 v125, v125, v152
v_fmac_f32 v125, v133, v154
v_fmac_f32 v125, v141, v156
v_fmac_f32 v125, v149, v158
v_min_u32 v125, 0xfffffffe, v125
v_mul_f32 v126, v126, v152
v_fmac_f32 v126, v134, v154
v_fmac_f32 v126, v142, v156
v_fmac_f32 v126, v150, v158
v_min_u32 v126, 0xfffffffe, v126
v_mul_f32 v127, v127, v152
v_fmac_f32 v127, v135, v154
v_fmac_f32 v127, v143, v156
v_fmac_f32 v127, v151, v158
v_min_u32 v127, 0xfffffffe, v127
v_min_u32 v116, 0xfffffffe, v116
v_min_u32 v117, 0xfffffffe, v117
s_add_u32 s59, s33, 0
s_lshl_b32 s60, s59, 14
s_lshl_b32 s61, s30, 8
s_add_u32 s60, s60, s61
s_add_u32 s60, s60, 262144
buffer_store_dwordx4 v[120:123], v106, s[12:15], s60 offen sc1
buffer_store_dwordx4 v[124:127], v106, s[12:15], s60 offen offset:16 sc1
s_lshl_b32 s60, s59, 9
s_lshl_b32 s61, s30, 3
s_add_u32 s60, s60, s61
s_add_u32 s60, s60, 131072
s_mov_b32 exec_lo, 0x01010101
s_mov_b32 exec_hi, 0x01010101
buffer_store_dwordx2 v[116:117], v107, s[12:15], s60 offen sc1
s_mov_b64 exec, -1
v_and_b32 v164, 7, v1
v_lshlrev_b32 v164, 3, v164
v_lshlrev_b32 v165, 2, v27
v_add_u32 v166, 16, v165
v_lshlrev_b32 v167, 3, v26
v_add_u32 v167, 151552, v167
s_mov_b32 s94, 0
L_mlw:
buffer_load_dwordx2 v[32:33], v164, s[12:15], s36 offen sc1
s_waitcnt vmcnt(0)
v_max_u32 v108, v32, v33
v_cmp_eq_u32 vcc, -1, v108
s_add_u32 s94, s94, 1
s_cmp_eq_u64 vcc, 0
s_cbranch_scc1 L_mlw_ok
s_sleep 64
s_cmp_lt_u32 s94, 65536
s_cbranch_scc1 L_mlw
L_mlw_ok:
s_mov_b32 s94, 0
buffer_load_dwordx4 v[32:35], v2, s[12:15], s38 offen sc1
buffer_load_dwordx4 v[36:39], v2, s[12:15], s38 offen offset:1024 sc1
buffer_load_dwordx2 v[40:41], v164, s[12:15], s36 offen sc1
buffer_load_dwordx4 v[48:51], v2, s[12:15], s38 offen sc1
buffer_load_dwordx4 v[52:55], v2, s[12:15], s38 offen offset:1024 sc1
buffer_load_dwordx2 v[56:57], v164, s[12:15], s36 offen sc1
L_g0_loop:
s_sleep 16
buffer_load_dwordx4 v[64:67], v2, s[12:15], s38 offen sc1
buffer_load_dwordx4 v[68:71], v2, s[12:15], s38 offen offset:1024 sc1
buffer_load_dwordx2 v[72:73], v164, s[12:15], s36 offen sc1
s_waitcnt vmcnt(6)
v_max_u32 v108, v32, v33
v_max3_u32 v108, v34, v35, v108
v_max3_u32 v108, v36, v37, v108
v_max3_u32 v108, v38, v39, v108
v_max3_u32 v108, v40, v41, v108
v_cmp_eq_u32 vcc, -1, v108
s_nop 1
s_cmp_eq_u64 vcc, 0
s_cbranch_scc1 L_g0_ok0
s_sleep 16
buffer_load_dwordx4 v[32:35], v2, s[12:15], s38 offen sc1
buffer_load_dwordx4 v[36:39], v2, s[12:15], s38 offen offset:1024 sc1
buffer_load_dwordx2 v[40:41], v164, s[12:15], s36 offen sc1
s_waitcnt vmcnt(6)
v_max_u32 v108, v48, v49
v_max3_u32 v108, v50, v51, v108
v_max3_u32 v108, v52, v53, v108
v_max3_u32 v108, v54, v55, v108
v_max3_u32 v108, v56, v57, v108
v_cmp_eq_u32 vcc, -1, v108
s_nop 1
s_cmp_eq_u64 vcc, 0
s_cbranch_scc1 L_g0_ok1
s_sleep 16
buffer_load_dwordx4 v[48:51], v2, s[12:15], s38 offen sc1
buffer_load_dwordx4 v[52:55], v2, s[12:15], s38 offen offset:1024 sc1
buffer_load_dwordx2 v[56:57], v164, s[12:15], s36 offen sc1
s_waitcnt vmcnt(6)
v_max_u32 v108, v64, v65
v_max3_u32 v108, v66, v67, v108
v_max3_u32 v108, v68, v69, v108
v_max3_u32 v108, v70, v71, v108
v_max3_u32 v108, v72, v73, v108
v_cmp_eq_u32 vcc, -1, v108
s_nop 1
s_cmp_eq_u64 vcc, 0
s_cbranch_scc1 L_g0_ok2
s_add_u32 s94, s94, 1
s_cmp_lt_u32 s94, 65536
s_cbranch_scc1 L_g0_loop
L_g0_ok0:
v_mov_b32 v120, v32
v_mov_b32 v121, v33
v_mov_b32 v122, v34
v_mov_b32 v123, v35
v_mov_b32 v124, v36
v_mov_b32 v125, v37
v_mov_b32 v126, v38
v_mov_b32 v127, v39
v_mov_b32 v128, v40
v_mov_b32 v129, v41
s_branch L_g0_done
L_g0_ok1:
v_mov_b32 v120, v48
v_mov_b32 v121, v49
v_mov_b32 v122, v50
v_mov_b32 v123, v51
v_mov_b32 v124, v52
v_mov_b32 v125, v53
v_mov_b32 v126, v54
v_mov_b32 v127, v55
v_mov_b32 v128, v56
v_mov_b32 v129, v57
s_branch L_g0_done
L_g0_ok2:
v_mov_b32 v120, v64
v_mov_b32 v121, v65
v_mov_b32 v122, v66
v_mov_b32 v123, v67
v_mov_b32 v124, v68
v_mov_b32 v125, v69
v_mov_b32 v126, v70
v_mov_b32 v127, v71
v_mov_b32 v128, v72
v_mov_b32 v129, v73
L_g0_done:
v_mov_b32 v130, v128
s_nop 1
v_max_f32_dpp v131, v130, v130 quad_perm:[1,0,3,2] row_mask:0xf bank_mask:0xf
v_mov_b32 v130, v131
s_nop 1
v_max_f32_dpp v131, v130, v130 quad_perm:[2,3,0,1] row_mask:0xf bank_mask:0xf
v_mov_b32 v130, v131
s_nop 1
v_max_f32_dpp v131, v130, v130 row_half_mirror row_mask:0xf bank_mask:0xf
v_mov_b32 v130, v131
v_sub_f32 v128, v128, v130
v_exp_f32 v128, v128
s_nop 0
v_mul_f32 v129, v129, v128
s_nop 1
v_add_f32_dpp v131, v129, v129 quad_perm:[1,0,3,2] row_mask:0xf bank_mask:0xf
v_mov_b32 v129, v131
s_nop 1
v_add_f32_dpp v131, v129, v129 quad_perm:[2,3,0,1] row_mask:0xf bank_mask:0xf
v_mov_b32 v129, v131
s_nop 1
v_add_f32_dpp v131, v129, v129 row_half_mirror row_mask:0xf bank_mask:0xf
v_mov_b32 v129, v131
v_rcp_f32 v129, v129
s_nop 0
v_mul_f32 v128, v128, v129
ds_bpermute_b32 v132, v165, v128
ds_bpermute_b32 v133, v166, v128
s_waitcnt lgkmcnt(0)
v_mul_f32 v120, v120, v132
v_fmac_f32 v120, v124, v133
v_mul_f32 v121, v121, v132
v_fmac_f32 v121, v125, v133
v_mul_f32 v122, v122, v132
v_fmac_f32 v122, v126, v133
v_mul_f32 v123, v123, v132
v_fmac_f32 v123, v127, v133
v_mov_b32 v124, v120
v_mov_b32 v125, v121
v_mov_b32 v126, v122
v_mov_b32 v127, v123
s_nop 1
v_permlane16_swap_b32 v120, v124
v_permlane16_swap_b32 v121, v125
v_permlane16_swap_b32 v122, v126
v_permlane16_swap_b32 v123, v127
s_nop 1
v_add_f32 v120, v120, v124
v_add_f32 v121, v121, v125
v_add_f32 v122, v122, v126
v_add_f32 v123, v123, v127
v_mov_b32 v124, v120
v_mov_b32 v125, v121
v_mov_b32 v126, v122
v_mov_b32 v127, v123
s_nop 1
v_permlane32_swap_b32 v120, v124
v_permlane32_swap_b32 v121, v125
v_permlane32_swap_b32 v122, v126
v_permlane32_swap_b32 v123, v127
s_nop 1
v_add_f32 v120, v120, v124
v_add_f32 v121, v121, v125
v_add_f32 v122, v122, v126
v_add_f32 v123, v123, v127
v_cvt_pk_bf16_f32 v134, v120, v121
v_cvt_pk_bf16_f32 v135, v122, v123
s_mov_b64 exec, 0xffff
ds_write_b64 v167, v[134:135] offset:0
s_mov_b64 exec, -1
s_waitcnt vmcnt(0)
s_mov_b32 s94, 0
L_hc_20_poll:
ds_read_b32 v108, v109 offset:4
s_waitcnt lgkmcnt(0)
v_readfirstlane_b32 s59, v108
s_nop 1
s_cmp_eq_u32 s59, 4
s_cbranch_scc1 L_hc_20_go
s_sleep 1
s_add_u32 s94, s94, 1
s_cmp_lt_u32 s94, 262144
s_cbranch_scc1 L_hc_20_poll
L_hc_20_go:
v_add_u32 v160, 16896, v104
v_add_u32 v161, 16896, v105
ds_read_b128 v[120:123], v160
ds_read_b128 v[124:127], v160 offset:16
ds_read_b64 v[152:153], v161 offset:2048
v_add_u32 v160, 50688, v104
v_add_u32 v161, 50688, v105
ds_read_b128 v[128:131], v160
ds_read_b128 v[132:135], v160 offset:16
ds_read_b64 v[154:155], v161 offset:2048
v_add_u32 v160, 84480, v104
v_add_u32 v161, 84480, v105
ds_read_b128 v[136:139], v160
ds_read_b128 v[140:143], v160 offset:16
ds_read_b64 v[156:157], v161 offset:2048
v_add_u32 v160, 118272, v104
v_add_u32 v161, 118272, v105
ds_read_b128 v[144:147], v160
ds_read_b128 v[148:151], v160 offset:16
ds_read_b64 v[158:159], v161 offset:2048
s_waitcnt lgkmcnt(0)
v_max_f32 v116, v152, v154
v_max3_f32 v116, v156, v158, v116
v_sub_f32 v152, v152, v116
v_sub_f32 v154, v154, v116
v_sub_f32 v156, v156, v116
v_sub_f32 v158, v158, v116
v_exp_f32 v152, v152
v_exp_f32 v154, v154
v_exp_f32 v156, v156
v_exp_f32 v158, v158
s_nop 0
v_mul_f32 v117, v152, v153
v_fmac_f32 v117, v154, v155
v_fmac_f32 v117, v156, v157
v_fmac_f32 v117, v158, v159
v_mul_f32 v120, v120, v152
v_fmac_f32 v120, v128, v154
v_fmac_f32 v120, v136, v156
v_fmac_f32 v120, v144, v158
v_min_u32 v120, 0xfffffffe, v120
v_mul_f32 v121, v121, v152
v_fmac_f32 v121, v129, v154
v_fmac_f32 v121, v137, v156
v_fmac_f32 v121, v145, v158
v_min_u32 v121, 0xfffffffe, v121
v_mul_f32 v122, v122, v152
v_fmac_f32 v122, v130, v154
v_fmac_f32 v122, v138, v156
v_fmac_f32 v122, v146, v158
v_min_u32 v122, 0xfffffffe, v122
v_mul_f32 v123, v123, v152
v_fmac_f32 v123, v131, v154
v_fmac_f32 v123, v139, v156
v_fmac_f32 v123, v147, v158
v_min_u32 v123, 0xfffffffe, v123
v_mul_f32 v124, v124, v152
v_fmac_f32 v124, v132, v154
v_fmac_f32 v124, v140, v156
v_fmac_f32 v124, v148, v158
v_min_u32 v124, 0xfffffffe, v124
v_mul_f32 v125, v125, v152
v_fmac_f32 v125, v133, v154
v_fmac_f32 v125, v141, v156
v_fmac_f32 v125, v149, v158
v_min_u32 v125, 0xfffffffe, v125
v_mul_f32 v126, v126, v152
v_fmac_f32 v126, v134, v154
v_fmac_f32 v126, v142, v156
v_fmac_f32 v126, v150, v158
v_min_u32 v126, 0xfffffffe, v126
v_mul_f32 v127, v127, v152
v_fmac_f32 v127, v135, v154
v_fmac_f32 v127, v143, v156
v_fmac_f32 v127, v151, v158
v_min_u32 v127, 0xfffffffe, v127
v_min_u32 v116, 0xfffffffe, v116
v_min_u32 v117, 0xfffffffe, v117
s_add_u32 s59, s33, 32
s_lshl_b32 s60, s59, 14
s_lshl_b32 s61, s30, 8
s_add_u32 s60, s60, s61
s_add_u32 s60, s60, 262144
buffer_store_dwordx4 v[120:123], v106, s[12:15], s60 offen sc1
buffer_store_dwordx4 v[124:127], v106, s[12:15], s60 offen offset:16 sc1
s_lshl_b32 s60, s59, 9
s_lshl_b32 s61, s30, 3
s_add_u32 s60, s60, s61
s_add_u32 s60, s60, 131072
s_mov_b32 exec_lo, 0x01010101
s_mov_b32 exec_hi, 0x01010101
buffer_store_dwordx2 v[116:117], v107, s[12:15], s60 offen sc1
s_mov_b64 exec, -1
s_mov_b32 s94, 0
buffer_load_dwordx4 v[32:35], v2, s[12:15], s39 offen sc1
buffer_load_dwordx4 v[36:39], v2, s[12:15], s39 offen offset:1024 sc1
buffer_load_dwordx2 v[40:41], v164, s[12:15], s37 offen sc1
buffer_load_dwordx4 v[48:51], v2, s[12:15], s39 offen sc1
buffer_load_dwordx4 v[52:55], v2, s[12:15], s39 offen offset:1024 sc1
buffer_load_dwordx2 v[56:57], v164, s[12:15], s37 offen sc1
L_g1_loop:
s_sleep 1
buffer_load_dwordx4 v[64:67], v2, s[12:15], s39 offen sc1
buffer_load_dwordx4 v[68:71], v2, s[12:15], s39 offen offset:1024 sc1
buffer_load_dwordx2 v[72:73], v164, s[12:15], s37 offen sc1
s_waitcnt vmcnt(6)
v_max_u32 v108, v32, v33
v_max3_u32 v108, v34, v35, v108
v_max3_u32 v108, v36, v37, v108
v_max3_u32 v108, v38, v39, v108
v_max3_u32 v108, v40, v41, v108
v_cmp_eq_u32 vcc, -1, v108
s_nop 1
s_cmp_eq_u64 vcc, 0
s_cbranch_scc1 L_g1_ok0
s_sleep 1
buffer_load_dwordx4 v[32:35], v2, s[12:15], s39 offen sc1
buffer_load_dwordx4 v[36:39], v2, s[12:15], s39 offen offset:1024 sc1
buffer_load_dwordx2 v[40:41], v164, s[12:15], s37 offen sc1
s_waitcnt vmcnt(6)
v_max_u32 v108, v48, v49
v_max3_u32 v108, v50, v51, v108
v_max3_u32 v108, v52, v53, v108
v_max3_u32 v108, v54, v55, v108
v_max3_u32 v108, v56, v57, v108
v_cmp_eq_u32 vcc, -1, v108
s_nop 1
s_cmp_eq_u64 vcc, 0
s_cbranch_scc1 L_g1_ok1
s_sleep 1
buffer_load_dwordx4 v[48:51], v2, s[12:15], s39 offen sc1
buffer_load_dwordx4 v[52:55], v2, s[12:15], s39 offen offset:1024 sc1
buffer_load_dwordx2 v[56:57], v164, s[12:15], s37 offen sc1
s_waitcnt vmcnt(6)
v_max_u32 v108, v64, v65
v_max3_u32 v108, v66, v67, v108
v_max3_u32 v108, v68, v69, v108
v_max3_u32 v108, v70, v71, v108
v_max3_u32 v108, v72, v73, v108
v_cmp_eq_u32 vcc, -1, v108
s_nop 1
s_cmp_eq_u64 vcc, 0
s_cbranch_scc1 L_g1_ok2
s_add_u32 s94, s94, 1
s_cmp_lt_u32 s94, 65536
s_cbranch_scc1 L_g1_loop
L_g1_ok0:
v_mov_b32 v120, v32
v_mov_b32 v121, v33
v_mov_b32 v122, v34
v_mov_b32 v123, v35
v_mov_b32 v124, v36
v_mov_b32 v125, v37
v_mov_b32 v126, v38
v_mov_b32 v127, v39
v_mov_b32 v128, v40
v_mov_b32 v129, v41
s_branch L_g1_done
L_g1_ok1:
v_mov_b32 v120, v48
v_mov_b32 v121, v49
v_mov_b32 v122, v50
v_mov_b32 v123, v51
v_mov_b32 v124, v52
v_mov_b32 v125, v53
v_mov_b32 v126, v54
v_mov_b32 v127, v55
v_mov_b32 v128, v56
v_mov_b32 v129, v57
s_branch L_g1_done
L_g1_ok2:
v_mov_b32 v120, v64
v_mov_b32 v121, v65
v_mov_b32 v122, v66
v_mov_b32 v123, v67
v_mov_b32 v124, v68
v_mov_b32 v125, v69
v_mov_b32 v126, v70
v_mov_b32 v127, v71
v_mov_b32 v128, v72
v_mov_b32 v129, v73
L_g1_done:
v_mov_b32 v130, v128
s_nop 1
v_max_f32_dpp v131, v130, v130 quad_perm:[1,0,3,2] row_mask:0xf bank_mask:0xf
v_mov_b32 v130, v131
s_nop 1
v_max_f32_dpp v131, v130, v130 quad_perm:[2,3,0,1] row_mask:0xf bank_mask:0xf
v_mov_b32 v130, v131
s_nop 1
v_max_f32_dpp v131, v130, v130 row_half_mirror row_mask:0xf bank_mask:0xf
v_mov_b32 v130, v131
v_sub_f32 v128, v128, v130
v_exp_f32 v128, v128
s_nop 0
v_mul_f32 v129, v129, v128
s_nop 1
v_add_f32_dpp v131, v129, v129 quad_perm:[1,0,3,2] row_mask:0xf bank_mask:0xf
v_mov_b32 v129, v131
s_nop 1
v_add_f32_dpp v131, v129, v129 quad_perm:[2,3,0,1] row_mask:0xf bank_mask:0xf
v_mov_b32 v129, v131
s_nop 1
v_add_f32_dpp v131, v129, v129 row_half_mirror row_mask:0xf bank_mask:0xf
v_mov_b32 v129, v131
v_rcp_f32 v129, v129
s_nop 0
v_mul_f32 v128, v128, v129
ds_bpermute_b32 v132, v165, v128
ds_bpermute_b32 v133, v166, v128
s_waitcnt lgkmcnt(0)
v_mul_f32 v120, v120, v132
v_fmac_f32 v120, v124, v133
v_mul_f32 v121, v121, v132
v_fmac_f32 v121, v125, v133
v_mul_f32 v122, v122, v132
v_fmac_f32 v122, v126, v133
v_mul_f32 v123, v123, v132
v_fmac_f32 v123, v127, v133
v_mov_b32 v124, v120
v_mov_b32 v125, v121
v_mov_b32 v126, v122
v_mov_b32 v127, v123
s_nop 1
v_permlane16_swap_b32 v120, v124
v_permlane16_swap_b32 v121, v125
v_permlane16_swap_b32 v122, v126
v_permlane16_swap_b32 v123, v127
s_nop 1
v_add_f32 v120, v120, v124
v_add_f32 v121, v121, v125
v_add_f32 v122, v122, v126
v_add_f32 v123, v123, v127
v_mov_b32 v124, v120
v_mov_b32 v125, v121
v_mov_b32 v126, v122
v_mov_b32 v127, v123
s_nop 1
v_permlane32_swap_b32 v120, v124
v_permlane32_swap_b32 v121, v125
v_permlane32_swap_b32 v122, v126
v_permlane32_swap_b32 v123, v127
s_nop 1
v_add_f32 v120, v120, v124
v_add_f32 v121, v121, v125
v_add_f32 v122, v122, v126
v_add_f32 v123, v123, v127
v_cvt_pk_bf16_f32 v134, v120, v121
v_cvt_pk_bf16_f32 v135, v122, v123
s_mov_b64 exec, 0xffff
ds_write_b64 v167, v[134:135] offset:128
s_mov_b64 exec, -1
s_waitcnt lgkmcnt(0)
s_barrier
s_and_b32 s58, s2, 31
s_cmp_ge_u32 s58, 28
s_cbranch_scc1 L_end
s_waitcnt vmcnt(0)
s_mov_b32 s94, 0
buffer_load_dwordx4 v[32:35], v2, s[12:15], s54 offen offset:0 sc1
buffer_load_dwordx4 v[36:39], v2, s[12:15], s54 offen offset:1024 sc1
buffer_load_dwordx4 v[40:43], v2, s[12:15], s54 offen offset:2048 sc1
buffer_load_dwordx4 v[44:47], v2, s[12:15], s54 offen offset:3072 sc1
buffer_load_dwordx4 v[48:51], v2, s[12:15], s54 offen offset:0 sc1
buffer_load_dwordx4 v[52:55], v2, s[12:15], s54 offen offset:1024 sc1
buffer_load_dwordx4 v[56:59], v2, s[12:15], s54 offen offset:2048 sc1
buffer_load_dwordx4 v[60:63], v2, s[12:15], s54 offen offset:3072 sc1
L_fin_loop:
s_sleep 1
buffer_load_dwordx4 v[64:67], v2, s[12:15], s54 offen offset:0 sc1
buffer_load_dwordx4 v[68:71], v2, s[12:15], s54 offen offset:1024 sc1
buffer_load_dwordx4 v[72:75], v2, s[12:15], s54 offen offset:2048 sc1
buffer_load_dwordx4 v[76:79], v2, s[12:15], s54 offen offset:3072 sc1
s_waitcnt vmcnt(8)
v_max_u32 v108, v32, v33
v_max3_u32 v108, v34, v35, v108
v_max3_u32 v108, v36, v37, v108
v_max3_u32 v108, v38, v39, v108
v_max3_u32 v108, v40, v41, v108
v_max3_u32 v108, v42, v43, v108
v_max3_u32 v108, v44, v45, v108
v_max3_u32 v108, v46, v47, v108
v_cmp_eq_u32 vcc, -1, v108
s_nop 1
s_cmp_eq_u64 vcc, 0
s_cbranch_scc1 L_fin_ok0
s_sleep 1
buffer_load_dwordx4 v[32:35], v2, s[12:15], s54 offen offset:0 sc1
buffer_load_dwordx4 v[36:39], v2, s[12:15], s54 offen offset:1024 sc1
buffer_load_dwordx4 v[40:43], v2, s[12:15], s54 offen offset:2048 sc1
buffer_load_dwordx4 v[44:47], v2, s[12:15], s54 offen offset:3072 sc1
s_waitcnt vmcnt(8)
v_max_u32 v108, v48, v49
v_max3_u32 v108, v50, v51, v108
v_max3_u32 v108, v52, v53, v108
v_max3_u32 v108, v54, v55, v108
v_max3_u32 v108, v56, v57, v108
v_max3_u32 v108, v58, v59, v108
v_max3_u32 v108, v60, v61, v108
v_max3_u32 v108, v62, v63, v108
v_cmp_eq_u32 vcc, -1, v108
s_nop 1
s_cmp_eq_u64 vcc, 0
s_cbranch_scc1 L_fin_ok1
s_sleep 1
buffer_load_dwordx4 v[48:51], v2, s[12:15], s54 offen offset:0 sc1
buffer_load_dwordx4 v[52:55], v2, s[12:15], s54 offen offset:1024 sc1
buffer_load_dwordx4 v[56:59], v2, s[12:15], s54 offen offset:2048 sc1
buffer_load_dwordx4 v[60:63], v2, s[12:15], s54 offen offset:3072 sc1
s_waitcnt vmcnt(8)
v_max_u32 v108, v64, v65
v_max3_u32 v108, v66, v67, v108
v_max3_u32 v108, v68, v69, v108
v_max3_u32 v108, v70, v71, v108
v_max3_u32 v108, v72, v73, v108
v_max3_u32 v108, v74, v75, v108
v_max3_u32 v108, v76, v77, v108
v_max3_u32 v108, v78, v79, v108
v_cmp_eq_u32 vcc, -1, v108
s_nop 1
s_cmp_eq_u64 vcc, 0
s_cbranch_scc1 L_fin_ok2
s_add_u32 s94, s94, 1
s_cmp_lt_u32 s94, 65536
s_cbranch_scc1 L_fin_loop
L_fin_ok0:
v_mov_b32 v120, v32
v_mov_b32 v121, v33
v_mov_b32 v122, v34
v_mov_b32 v123, v35
v_mov_b32 v124, v36
v_mov_b32 v125, v37
v_mov_b32 v126, v38
v_mov_b32 v127, v39
v_mov_b32 v128, v40
v_mov_b32 v129, v41
v_mov_b32 v130, v42
v_mov_b32 v131, v43
v_mov_b32 v132, v44
v_mov_b32 v133, v45
v_mov_b32 v134, v46
v_mov_b32 v135, v47
s_branch L_fin_done
L_fin_ok1:
v_mov_b32 v120, v48
v_mov_b32 v121, v49
v_mov_b32 v122, v50
v_mov_b32 v123, v51
v_mov_b32 v124, v52
v_mov_b32 v125, v53
v_mov_b32 v126, v54
v_mov_b32 v127, v55
v_mov_b32 v128, v56
v_mov_b32 v129, v57
v_mov_b32 v130, v58
v_mov_b32 v131, v59
v_mov_b32 v132, v60
v_mov_b32 v133, v61
v_mov_b32 v134, v62
v_mov_b32 v135, v63
s_branch L_fin_done
L_fin_ok2:
v_mov_b32 v120, v64
v_mov_b32 v121, v65
v_mov_b32 v122, v66
v_mov_b32 v123, v67
v_mov_b32 v124, v68
v_mov_b32 v125, v69
v_mov_b32 v126, v70
v_mov_b32 v127, v71
v_mov_b32 v128, v72
v_mov_b32 v129, v73
v_mov_b32 v130, v74
v_mov_b32 v131, v75
v_mov_b32 v132, v76
v_mov_b32 v133, v77
v_mov_b32 v134, v78
v_mov_b32 v135, v79
L_fin_done:
v_add_f32 v120, v120, v124
v_add_f32 v128, v128, v132
v_add_f32 v120, v120, v128
v_add_f32 v121, v121, v125
v_add_f32 v129, v129, v133
v_add_f32 v121, v121, v129
v_add_f32 v122, v122, v126
v_add_f32 v130, v130, v134
v_add_f32 v122, v122, v130
v_add_f32 v123, v123, v127
v_add_f32 v131, v131, v135
v_add_f32 v123, v123, v131
s_nop 1
v_add_f32_dpp v124, v120, v120 row_ror:4 row_mask:0xf bank_mask:0xf
v_add_f32_dpp v125, v121, v121 row_ror:4 row_mask:0xf bank_mask:0xf
v_add_f32_dpp v126, v122, v122 row_ror:4 row_mask:0xf bank_mask:0xf
v_add_f32_dpp v127, v123, v123 row_ror:4 row_mask:0xf bank_mask:0xf
v_mov_b32 v120, v124
v_mov_b32 v121, v125
v_mov_b32 v122, v126
v_mov_b32 v123, v127
s_nop 1
v_add_f32_dpp v124, v120, v120 row_ror:8 row_mask:0xf bank_mask:0xf
v_add_f32_dpp v125, v121, v121 row_ror:8 row_mask:0xf bank_mask:0xf
v_add_f32_dpp v126, v122, v122 row_ror:8 row_mask:0xf bank_mask:0xf
v_add_f32_dpp v127, v123, v123 row_ror:8 row_mask:0xf bank_mask:0xf
v_mov_b32 v120, v124
v_mov_b32 v121, v125
v_mov_b32 v122, v126
v_mov_b32 v123, v127
v_mov_b32 v124, v120
v_mov_b32 v125, v121
v_mov_b32 v126, v122
v_mov_b32 v127, v123
s_nop 1
v_permlane16_swap_b32 v120, v124
v_permlane16_swap_b32 v121, v125
v_permlane16_swap_b32 v122, v126
v_permlane16_swap_b32 v123, v127
s_nop 1
v_add_f32 v120, v120, v124
v_add_f32 v121, v121, v125
v_add_f32 v122, v122, v126
v_add_f32 v123, v123, v127
v_mov_b32 v124, v120
v_mov_b32 v125, v121
v_mov_b32 v126, v122
v_mov_b32 v127, v123
s_nop 1
v_permlane32_swap_b32 v120, v124
v_permlane32_swap_b32 v121, v125
v_permlane32_swap_b32 v122, v126
v_permlane32_swap_b32 v123, v127
s_nop 1
v_add_f32 v120, v120, v124
v_add_f32 v121, v121, v125
v_add_f32 v122, v122, v126
v_add_f32 v123, v123, v127
v_cvt_pk_bf16_f32 v152, v120, v121
v_cvt_pk_bf16_f32 v153, v122, v123
s_lshr_b32 s59, s2, 5
s_mul_i32 s59, s59, 896
s_lshl_b32 s58, s58, 5
s_add_u32 s59, s59, s58
v_lshlrev_b32 v104, 3, v1
s_mov_b64 exec, 15
buffer_store_dwordx2 v[152:153], v104, s[24:27], s59 offen
s_mov_b64 exec, -1
L_end:
s_endpgm
.section .rodata,"a"
.p2align 6
.amdhsa_kernel standalone__gqa_block_cached__sampling_kernel
  .amdhsa_next_free_vgpr 192
  .amdhsa_next_free_sgpr 100
  .amdhsa_accum_offset 192
  .amdhsa_group_segment_fixed_size 0
  .amdhsa_kernarg_size 64
  .amdhsa_user_sgpr_count 2
  .amdhsa_user_sgpr_kernarg_segment_ptr 1
  .amdhsa_system_sgpr_workgroup_id_x 1
.end_amdhsa_kernel
```
